```python
import torch

def _softmax(x, axis=-1):
    return torch.softmax(x, dim=axis)
def _gelu(x):
    return torch.nn.functional.gelu(x, approximate="tanh")
def _silu(x):
    return torch.nn.functional.silu(x)
def _sigmoid(x):
    return torch.sigmoid(x)
def _layernorm(x, axis=-1, eps=1e-5):
    m = x.mean(dim=axis, keepdim=True)
    v = x.var(dim=axis, keepdim=True, unbiased=False)
    return (x - m) / torch.sqrt(v + eps)
def _scatter_add(tgt, idx, src, axis=0):
    return tgt.clone().index_add_(axis, idx, src)
def _segment_sum(src, seg, n):
    out = torch.zeros((n,) + src.shape[1:], dtype=src.dtype)
    return out.index_add_(0, seg, src)
def _pad(x, pw):
    flat = tuple(v for pair in reversed(pw) for v in pair)
    return torch.nn.functional.pad(x, flat)

kernel_name = 'standalone__detection_seg_mask2former__vision'

def setup_inputs():

    _w = (lambda a: (lambda t: t.to(torch.bfloat16) if t.is_floating_point() else t)(torch.as_tensor(a)))
    H = W = 224
    C = 192
    Hc, Wc = H // 2, W // 2
    nh = 4
    Nq = 16
    sc = C ** -0.5
    return {
        "q": _w((lambda *s: torch.randn(*s, dtype=torch.bfloat16) * 0.2)(1, Nq, C)),
        "f_hi": _w((lambda *s: torch.randn(*s, dtype=torch.bfloat16) * 0.2)(1, H, W, C)),
        "f_lo": _w((lambda *s: torch.randn(*s, dtype=torch.bfloat16) * 0.4)(1, Hc, Wc, C)),
        "w_lat": _w((lambda *s: torch.randn(*s, dtype=torch.bfloat16) * 0.4)(C, C) * sc),
        "w_q": _w((lambda *s: torch.randn(*s, dtype=torch.bfloat16) * 3.2)(nh, C, C // nh) * sc),
        "w_k": _w((lambda *s: torch.randn(*s, dtype=torch.bfloat16) * 3.2)(nh, C, C // nh) * sc),
        "w_v": _w((lambda *s: torch.randn(*s, dtype=torch.bfloat16) * 3.2)(nh, C, C // nh) * sc),
        "w_o": _w((lambda *s: torch.randn(*s, dtype=torch.bfloat16) * 3.2)(C, C) * sc),
        "w_m": _w((lambda *s: torch.randn(*s, dtype=torch.bfloat16) * 3.2)(C, C) * sc),
    }

def reference(q, f_hi, f_lo, w_lat, w_q, w_k, w_v, w_o, w_m):
    B, Nq, C = q.shape
    _, H, W, _ = f_hi.shape
    nh = w_q.shape[0]
    dh = C // nh
    up = (lambda x, n, axis: torch.repeat_interleave(x, n, dim=axis))((lambda x, n, axis: torch.repeat_interleave(x, n, dim=axis))(f_lo, 2, axis=1), 2, axis=2)
    feat = f_hi + up @ w_lat
    feat = _layernorm(feat, axis=-1)
    kv = feat.reshape(B, H * W, C)
    m_embed = q @ w_m
    mask_bias = torch.einsum('bqc,bkc->bqk', m_embed, kv) * (C ** -0.5)
    Q = torch.einsum('bqc,hcd->bhqd', q, w_q)
    K = torch.einsum('bkc,hcd->bhkd', kv, w_k)
    V = torch.einsum('bkc,hcd->bhkd', kv, w_v)
    logits = torch.einsum('bhqd,bhkd->bhqk', Q, K) * (dh ** -0.5)
    logits = logits + mask_bias[:, None, :, :]
    attn = _softmax(logits, axis=-1)
    ctx = torch.einsum('bhqk,bhkd->bqhd', attn, V).reshape(B, Nq, C)
    return q + ctx @ w_o
```

```asm
; @launch grid=(256,1,1) block=(512,1,1) lds=163840
.amdgcn_target "amdgcn-amd-amdhsa--gfx950"
.text
.globl standalone__detection_seg_mask2former__vision_kernel
.p2align 8
.type standalone__detection_seg_mask2former__vision_kernel,@function
standalone__detection_seg_mask2former__vision_kernel:
    s_cmp_ge_u32 s2, 256
    s_cbranch_scc1 L_end

    s_load_dwordx16 s[16:31], s[0:1], 0
    s_load_dwordx8 s[32:39], s[0:1], 64
    s_getpc_b64 s[94:95]
    v_lshrrev_b32 v1, 6, v0
    s_nop 0
    v_readfirstlane_b32 s3, v1
    s_sub_u32 s15, s2, 32
    s_cmp_lt_u32 s2, 32
    s_cbranch_scc0 L_worker
    s_lshr_b32 s15, s2, 4
    s_lshl_b32 s15, s15, 2
    s_add_u32 s15, s15, s2
    s_and_b32 s15, s15, 15

    v_and_b32 v1, 63, v0
    v_lshrrev_b32 v2, 4, v1
    v_and_b32 v3, 15, v1
    s_lshr_b32 s4, s15, 2
    s_and_b32 s5, s15, 3
    v_lshlrev_b32 v4, 4, v1

    v_add_u32 v5, 0, v1
    v_mul_u32_u24 v6, 10923, v5
    v_lshrrev_b32 v6, 16, v6
    v_mul_u32_u24 v7, 6, v6
    v_sub_u32 v7, v5, v7
    v_mul_u32_u24 v6, 384, v6
    v_lshlrev_b32 v7, 4, v7
    v_add_u32 v8, v6, v7

    v_add_u32 v5, 64, v1
    v_mul_u32_u24 v6, 10923, v5
    v_lshrrev_b32 v6, 16, v6
    v_mul_u32_u24 v7, 6, v6
    v_sub_u32 v7, v5, v7
    v_mul_u32_u24 v6, 384, v6
    v_lshlrev_b32 v7, 4, v7
    v_add_u32 v9, v6, v7

    v_add_u32 v5, 128, v1
    v_mul_u32_u24 v6, 10923, v5
    v_lshrrev_b32 v6, 16, v6
    v_mul_u32_u24 v7, 6, v6
    v_sub_u32 v7, v5, v7
    v_mul_u32_u24 v6, 384, v6
    v_lshlrev_b32 v7, 4, v7
    v_add_u32 v10, v6, v7

    v_add_u32 v16, 0, v4
    v_add_u32 v17, 1024, v4
    v_add_u32 v18, 2048, v4
    s_mul_i32 s6, s4, 18432
    s_mul_i32 s11, s5, 96
    s_mul_i32 s10, s5, 4608
    s_add_u32 s10, s10, s6
    s_cmp_lt_u32 s3, 2
    s_cselect_b64 vcc, -1, 0
    v_cndmask_b32 v20, v8, v16, vcc
    v_cndmask_b32 v21, v9, v17, vcc
    v_cndmask_b32 v22, v10, v18, vcc
    s_mov_b32 s7, 12288
    s_cselect_b32 s7, 3072, s7
    s_mul_i32 s8, s3, 12288
    s_add_u32 s8, s8, s6
    s_sub_u32 s9, s3, 2
    s_mul_i32 s9, s9, 49152
    s_add_u32 s9, s9, s11
    s_cmp_lt_u32 s3, 2
    s_cselect_b32 s12, s8, s9
    s_mul_i32 s8, s3, 12288
    s_add_u32 s8, s8, 0
    s_sub_u32 s9, s3, 2
    s_mul_i32 s9, s9, 12288
    s_add_u32 s9, s9, 18432
    s_cmp_lt_u32 s3, 2
    s_cselect_b32 s13, s8, s9
    s_cmp_eq_u32 s3, 2
    s_cselect_b64 vcc, -1, 0
    v_cndmask_b32 v23, v16, v8, vcc
    v_cndmask_b32 v24, v17, v9, vcc
    v_cndmask_b32 v25, v18, v10, vcc
    s_mov_b32 s14, 3072
    s_cselect_b32 s14, 12288, s14
    s_add_u32 s8, s6, 6144
    s_add_u32 s9, s11, 24576
    s_cmp_eq_u32 s3, 0
    s_cselect_b32 s96, s8, 0
    s_cmp_eq_u32 s3, 2
    s_cselect_b32 s96, s9, s96
    s_cmp_eq_u32 s3, 3
    s_cselect_b32 s96, s10, s96
    s_mov_b32 s97, 6144
    s_cmp_eq_u32 s3, 1
    s_cselect_b32 s97, 36864, s97
    s_cmp_eq_u32 s3, 2
    s_cselect_b32 s97, 24576, s97
    s_cmp_eq_u32 s3, 3
    s_cselect_b32 s97, 43008, s97
    s_cmp_ge_u32 s3, 4
    s_cbranch_scc1 L_h_w4
    s_waitcnt lgkmcnt(0)
    s_cmp_lt_u32 s3, 2
    s_cselect_b32 s68, s24, s32
    s_cselect_b32 s69, s25, s33
    s_mov_b32 s70, 73728
    s_mov_b32 s71, 0x00020000

    s_add_u32 m0, s13, 0
    s_nop 0
    buffer_load_dwordx4 v20, s[68:71], s12 offen  lds
    s_add_u32 m0, s13, 1024
    s_nop 0
    buffer_load_dwordx4 v21, s[68:71], s12 offen  lds
    s_add_u32 m0, s13, 2048
    s_nop 0
    buffer_load_dwordx4 v22, s[68:71], s12 offen  lds
    s_add_u32 s12, s12, s7
    s_add_u32 m0, s13, 3072
    s_nop 0
    buffer_load_dwordx4 v20, s[68:71], s12 offen  lds
    s_add_u32 m0, s13, 4096
    s_nop 0
    buffer_load_dwordx4 v21, s[68:71], s12 offen  lds
    s_add_u32 m0, s13, 5120
    s_nop 0
    buffer_load_dwordx4 v22, s[68:71], s12 offen  lds
    s_cmp_eq_u32 s3, 0
    s_cselect_b32 s72, s24, s16
    s_cselect_b32 s73, s25, s17
    s_mov_b32 s74, 6144
    s_cselect_b32 s74, 73728, s74
    s_cmp_eq_u32 s3, 2
    s_cselect_b32 s72, s32, s72
    s_cselect_b32 s73, s33, s73
    s_cselect_b32 s74, 73728, s74
    s_cmp_eq_u32 s3, 3
    s_cselect_b32 s72, s26, s72
    s_cselect_b32 s73, s27, s73
    s_cselect_b32 s74, 73728, s74
    s_mov_b32 s75, 0x00020000

    s_add_u32 m0, s97, 0
    s_nop 0
    buffer_load_dwordx4 v23, s[72:75], s96 offen  lds
    s_add_u32 m0, s97, 1024
    s_nop 0
    buffer_load_dwordx4 v24, s[72:75], s96 offen  lds
    s_add_u32 m0, s97, 2048
    s_nop 0
    buffer_load_dwordx4 v25, s[72:75], s96 offen  lds
    s_add_u32 s96, s96, s14
    s_add_u32 m0, s97, 3072
    s_nop 0
    buffer_load_dwordx4 v23, s[72:75], s96 offen  lds
    s_add_u32 m0, s97, 4096
    s_nop 0
    buffer_load_dwordx4 v24, s[72:75], s96 offen  lds
    s_cmp_eq_u32 s3, 3
    s_cbranch_scc1 L_h_dma2
    s_add_u32 m0, s97, 5120
    s_nop 0
    buffer_load_dwordx4 v25, s[72:75], s96 offen  lds
    s_branch L_h_dma2
L_h_w4:
    s_waitcnt lgkmcnt(0)
L_h_dma2:
    s_load_dword s91, s[38:39], 0xc000
    s_mov_b32 s56, s38
    s_mov_b32 s57, s39
    s_mov_b32 s58, 268435456
    s_mov_b32 s59, 0x00020000
    s_mov_b32 s80, s30
    s_mov_b32 s81, s31
    s_mov_b32 s82, 73728
    s_mov_b32 s83, 0x00020000
    s_mov_b32 s84, s34
    s_mov_b32 s85, s35
    s_mov_b32 s86, 6144
    s_mov_b32 s87, 0x00020000
    s_mov_b32 s64, s16
    s_mov_b32 s65, s17
    s_mov_b32 s66, 6144
    s_mov_b32 s67, 0x00020000
    v_lshrrev_b32 v5, 2, v3
    v_and_b32 v6, 3, v3
    v_lshlrev_b32 v7, 3, v2
    v_add_u32 v7, v7, v5
    v_mul_u32_u24 v7, 96, v7
    v_lshlrev_b32 v6, 3, v6
    v_add_u32 v7, v7, v6
    s_lshl_b32 s8, s3, 5
    v_add_u32 v15, s8, v7
    v_add_u32 v15, 18432, v15
    v_mul_u32_u24 v12, 384, v3
    v_lshlrev_b32 v13, 4, v2
    v_add_u32 v12, v12, v13
    v_add_u32 v12, 36864, v12
    s_mul_i32 s8, s3, 1536
    v_mul_u32_u24 v14, 96, v3
    v_lshlrev_b32 v13, 3, v2
    v_add3_u32 v14, v14, v13, s8
    v_add_u32 v14, 43008, v14
    v_lshrrev_b32 v5, 1, v2
    v_and_b32 v6, 1, v2
    v_xor_b32 v6, v6, v5
    v_lshlrev_b32 v6, 3, v6
    v_lshlrev_b32 v13, 1, v3
    v_add_u32 v13, v13, v5
    v_mul_u32_u24 v13, 48, v13
    s_lshl_b32 s8, s3, 4
    v_add3_u32 v13, v13, v6, s8
    v_add_u32 v13, 48128, v13
    v_lshlrev_b32 v5, 1, v3
    v_add_u32 v5, s3, v5
    v_mul_u32_u24 v5, 48, v5
    v_mul_u32_u24 v6, 12, v2
    v_add_u32 v5, v5, v6
    v_add_u32 v46, 48128, v5
    v_lshlrev_b32 v5, 10, v2
    v_lshlrev_b32 v6, 4, v3
    v_add_u32 v47, v5, v6
    s_lshr_b32 s10, s4, 1
    s_lshl_b32 s10, s10, 4
    s_lshl_b32 s11, s5, 2
    s_add_u32 s10, s10, s11
    s_lshl_b32 s10, s10, 10
    s_lshl_b32 s11, s3, 9
    s_add_u32 s10, s10, s11
    s_and_b32 s11, s4, 1
    s_lshl_b32 s11, s11, 8
    s_add_u32 s10, s10, s11
    s_add_u32 s10, s10, 0

    s_waitcnt lgkmcnt(0)
    s_add_u32 s90, s91, 1
    s_and_b32 s89, s90, 0xffff
    s_cmp_ge_u32 s3, 4
    s_cbranch_scc1 L_h_b1
    s_waitcnt vmcnt(0)
L_h_b1:
    s_barrier
    s_cmp_ge_u32 s3, 3
    s_cbranch_scc1 L_h_b2

    ds_read_b128 v[16:19], v12 offset:0
    ds_read_b128 v[20:23], v12 offset:64
    ds_read_b128 v[24:27], v12 offset:128
    ds_read_b128 v[28:31], v12 offset:192
    ds_read_b128 v[32:35], v12 offset:256
    ds_read_b128 v[36:39], v12 offset:320
    ds_read_b64 v[40:41], v14 offset:0
    ds_read_b64 v[42:43], v14 offset:32
    ds_read_b64 v[44:45], v14 offset:64
    s_waitcnt lgkmcnt(0)
    ds_read_b64_tr_b16 v[64:65], v7 offset:0
    ds_read_b64_tr_b16 v[66:67], v7 offset:384
    ds_read_b64_tr_b16 v[68:69], v7 offset:32
    ds_read_b64_tr_b16 v[70:71], v7 offset:416
    ds_read_b64_tr_b16 v[72:73], v7 offset:64
    ds_read_b64_tr_b16 v[74:75], v7 offset:448
    ds_read_b64_tr_b16 v[76:77], v7 offset:3072
    ds_read_b64_tr_b16 v[78:79], v7 offset:3456
    ds_read_b64_tr_b16 v[80:81], v7 offset:3104
    ds_read_b64_tr_b16 v[82:83], v7 offset:3488
    ds_read_b64_tr_b16 v[84:85], v7 offset:3136
    ds_read_b64_tr_b16 v[86:87], v7 offset:3520
    ds_read_b64_tr_b16 v[88:89], v7 offset:6144
    ds_read_b64_tr_b16 v[90:91], v7 offset:6528
    s_waitcnt lgkmcnt(12)
    v_mfma_f32_16x16x32_bf16 v[48:51], v[64:67], v[16:19], 0
    ds_read_b64_tr_b16 v[64:65], v7 offset:6176
    ds_read_b64_tr_b16 v[66:67], v7 offset:6560
    s_waitcnt lgkmcnt(12)
    v_mfma_f32_16x16x32_bf16 v[52:55], v[68:71], v[16:19], 0
    ds_read_b64_tr_b16 v[68:69], v7 offset:6208
    ds_read_b64_tr_b16 v[70:71], v7 offset:6592
    s_waitcnt lgkmcnt(12)
    v_mfma_f32_16x16x32_bf16 v[56:59], v[72:75], v[16:19], 0
    ds_read_b64_tr_b16 v[72:73], v7 offset:9216
    ds_read_b64_tr_b16 v[74:75], v7 offset:9600
    s_waitcnt lgkmcnt(12)
    v_mfma_f32_16x16x32_bf16 v[48:51], v[76:79], v[20:23], v[48:51]
    ds_read_b64_tr_b16 v[76:77], v7 offset:9248
    ds_read_b64_tr_b16 v[78:79], v7 offset:9632
    s_waitcnt lgkmcnt(12)
    v_mfma_f32_16x16x32_bf16 v[52:55], v[80:83], v[20:23], v[52:55]
    ds_read_b64_tr_b16 v[80:81], v7 offset:9280
    ds_read_b64_tr_b16 v[82:83], v7 offset:9664
    s_waitcnt lgkmcnt(12)
    v_mfma_f32_16x16x32_bf16 v[56:59], v[84:87], v[20:23], v[56:59]
    ds_read_b64_tr_b16 v[84:85], v7 offset:12288
    ds_read_b64_tr_b16 v[86:87], v7 offset:12672
    s_waitcnt lgkmcnt(12)
    v_mfma_f32_16x16x32_bf16 v[48:51], v[88:91], v[24:27], v[48:51]
    ds_read_b64_tr_b16 v[88:89], v7 offset:12320
    ds_read_b64_tr_b16 v[90:91], v7 offset:12704
    s_waitcnt lgkmcnt(12)
    v_mfma_f32_16x16x32_bf16 v[52:55], v[64:67], v[24:27], v[52:55]
    ds_read_b64_tr_b16 v[64:65], v7 offset:12352
    ds_read_b64_tr_b16 v[66:67], v7 offset:12736
    s_waitcnt lgkmcnt(12)
    v_mfma_f32_16x16x32_bf16 v[56:59], v[68:71], v[24:27], v[56:59]
    ds_read_b64_tr_b16 v[68:69], v7 offset:15360
    ds_read_b64_tr_b16 v[70:71], v7 offset:15744
    s_waitcnt lgkmcnt(12)
    v_mfma_f32_16x16x32_bf16 v[48:51], v[72:75], v[28:31], v[48:51]
    ds_read_b64_tr_b16 v[72:73], v7 offset:15392
    ds_read_b64_tr_b16 v[74:75], v7 offset:15776
    s_waitcnt lgkmcnt(12)
    v_mfma_f32_16x16x32_bf16 v[52:55], v[76:79], v[28:31], v[52:55]
    ds_read_b64_tr_b16 v[76:77], v7 offset:15424
    ds_read_b64_tr_b16 v[78:79], v7 offset:15808
    s_waitcnt lgkmcnt(12)
    v_mfma_f32_16x16x32_bf16 v[56:59], v[80:83], v[28:31], v[56:59]
    ds_read_b64_tr_b16 v[96:97], v15 offset:0
    ds_read_b64_tr_b16 v[98:99], v15 offset:384
    s_waitcnt lgkmcnt(12)
    v_mfma_f32_16x16x32_bf16 v[48:51], v[84:87], v[32:35], v[48:51]
    ds_read_b64_tr_b16 v[100:101], v15 offset:3072
    ds_read_b64_tr_b16 v[102:103], v15 offset:3456
    s_waitcnt lgkmcnt(12)
    v_mfma_f32_16x16x32_bf16 v[52:55], v[88:91], v[32:35], v[52:55]
    ds_read_b64_tr_b16 v[104:105], v15 offset:6144
    ds_read_b64_tr_b16 v[106:107], v15 offset:6528
    s_waitcnt lgkmcnt(12)
    v_mfma_f32_16x16x32_bf16 v[56:59], v[64:67], v[32:35], v[56:59]
    ds_read_b64_tr_b16 v[108:109], v15 offset:9216
    ds_read_b64_tr_b16 v[110:111], v15 offset:9600
    s_waitcnt lgkmcnt(12)
    v_mfma_f32_16x16x32_bf16 v[48:51], v[68:71], v[36:39], v[48:51]
    ds_read_b64_tr_b16 v[112:113], v15 offset:12288
    ds_read_b64_tr_b16 v[114:115], v15 offset:12672
    s_waitcnt lgkmcnt(12)
    v_mfma_f32_16x16x32_bf16 v[52:55], v[72:75], v[36:39], v[52:55]
    ds_read_b64_tr_b16 v[116:117], v15 offset:15360
    ds_read_b64_tr_b16 v[118:119], v15 offset:15744
    s_waitcnt lgkmcnt(12)
    v_mfma_f32_16x16x32_bf16 v[56:59], v[76:79], v[36:39], v[56:59]
    s_waitcnt lgkmcnt(10)
    v_mfma_f32_16x16x32_bf16 v[60:63], v[96:99], v[16:19], 0
    v_cvt_pk_bf16_f32 v128, v48, v49
    v_cvt_pk_bf16_f32 v129, v50, v51
    s_waitcnt lgkmcnt(8)
    v_mfma_f32_16x16x32_bf16 v[124:127], v[100:103], v[20:23], 0
    v_cvt_pk_bf16_f32 v130, v52, v53
    v_cvt_pk_bf16_f32 v131, v54, v55
    s_waitcnt lgkmcnt(6)
    v_mfma_f32_16x16x32_bf16 v[60:63], v[104:107], v[24:27], v[60:63]
    v_cvt_pk_bf16_f32 v132, v56, v57
    v_cvt_pk_bf16_f32 v133, v58, v59
    s_waitcnt lgkmcnt(4)
    v_mfma_f32_16x16x32_bf16 v[124:127], v[108:111], v[28:31], v[124:127]
    s_waitcnt lgkmcnt(2)
    v_mfma_f32_16x16x32_bf16 v[60:63], v[112:115], v[32:35], v[60:63]
    s_waitcnt lgkmcnt(0)
    v_mfma_f32_16x16x32_bf16 v[124:127], v[116:119], v[36:39], v[124:127]
    v_mfma_f32_16x16x16_bf16 v[136:139], v[40:41], v[128:129], 0
    v_mfma_f32_16x16x16_bf16 v[136:139], v[42:43], v[130:131], v[136:139]
    v_mfma_f32_16x16x16_bf16 v[136:139], v[44:45], v[132:133], v[136:139]
    s_mov_b32 s8, 0x3e553b95
    s_mov_b32 s9, 0x3dd53b95
    s_nop 2
    v_add_f32 v60, v60, v124
    v_add_f32 v61, v61, v125
    v_add_f32 v62, v62, v126
    v_add_f32 v63, v63, v127
    v_mul_f32 v60, s9, v60
    v_mul_f32 v61, s9, v61
    v_mul_f32 v62, s9, v62
    v_mul_f32 v63, s9, v63
    v_fma_f32 v60, v136, s8, v60
    v_fma_f32 v61, v137, s8, v61
    v_fma_f32 v62, v138, s8, v62
    v_fma_f32 v63, v139, s8, v63
    v_cvt_pk_bf16_f32 v116, v60, v61
    v_cvt_pk_bf16_f32 v117, v62, v63
    ds_write_b64 v13, v[116:117]
    s_waitcnt lgkmcnt(0)
L_h_b2:

    s_barrier
    s_cmp_ge_u32 s3, 2
    s_cbranch_scc1 L_h_wo
    ds_read_b32 v116, v46
    ds_read_b32 v117, v46 offset:4
    ds_read_b32 v118, v46 offset:8
    v_mov_b32 v119, s90
    s_waitcnt lgkmcnt(0)
    buffer_store_dwordx4 v[116:119], v47, s[56:59], s10 offen sc1

    s_cmp_ge_u32 s2, 16
    s_cbranch_scc1 L_end
    s_barrier
    s_branch L_h_wo2
L_h_wo:
    s_cmp_ge_u32 s2, 16
    s_cbranch_scc1 L_end
    s_sub_u32 s7, s3, 2
    s_mul_i32 s7, s7, 12288
    s_barrier
    s_add_u32 m0, s7, 51200
    s_add_u32 s8, s7, 0
    buffer_load_dwordx4 v4, s[80:83], s8 offen lds

    s_add_u32 m0, s7, 52224
    s_add_u32 s8, s7, 1024
    buffer_load_dwordx4 v4, s[80:83], s8 offen lds

    s_add_u32 m0, s7, 53248
    s_add_u32 s8, s7, 2048
    buffer_load_dwordx4 v4, s[80:83], s8 offen lds

    s_add_u32 m0, s7, 54272
    s_add_u32 s8, s7, 3072
    buffer_load_dwordx4 v4, s[80:83], s8 offen lds

    s_add_u32 m0, s7, 55296
    s_add_u32 s8, s7, 4096
    buffer_load_dwordx4 v4, s[80:83], s8 offen lds

    s_add_u32 m0, s7, 56320
    s_add_u32 s8, s7, 5120
    buffer_load_dwordx4 v4, s[80:83], s8 offen lds

    s_add_u32 m0, s7, 57344
    s_add_u32 s8, s7, 6144
    buffer_load_dwordx4 v4, s[80:83], s8 offen lds

    s_add_u32 m0, s7, 58368
    s_add_u32 s8, s7, 7168
    buffer_load_dwordx4 v4, s[80:83], s8 offen lds

    s_add_u32 m0, s7, 59392
    s_add_u32 s8, s7, 8192
    buffer_load_dwordx4 v4, s[80:83], s8 offen lds

    s_add_u32 m0, s7, 60416
    s_add_u32 s8, s7, 9216
    buffer_load_dwordx4 v4, s[80:83], s8 offen lds

    s_add_u32 m0, s7, 61440
    s_add_u32 s8, s7, 10240
    buffer_load_dwordx4 v4, s[80:83], s8 offen lds

    s_add_u32 m0, s7, 62464
    s_add_u32 s8, s7, 11264
    buffer_load_dwordx4 v4, s[80:83], s8 offen lds

L_h_wo2:
    s_cmp_ge_u32 s2, 16
    s_cbranch_scc1 L_end
    s_mul_i32 s27, s15, 384
    s_lshl_b32 s9, s3, 6
    s_add_u32 s27, s27, s9
    v_lshlrev_b32 v8, 1, v3
    buffer_load_ushort v176, v8, s[64:67], s27 offen
    buffer_load_ushort v177, v8, s[64:67], s27 offen offset:32
    v_lshrrev_b32 v5, 2, v3
    v_and_b32 v6, 3, v3
    v_lshlrev_b32 v7, 3, v2
    v_add_u32 v7, v7, v5
    v_mul_u32_u24 v7, 384, v7
    v_lshlrev_b32 v6, 3, v6
    v_add_u32 v7, v7, v6
    s_lshl_b32 s8, s3, 6
    v_add_u32 v7, s8, v7
    v_add_u32 v7, 51200, v7
    s_lshr_b32 s4, s3, 1
    s_and_b32 s5, s3, 1
    s_lshl_b32 s6, s15, 2
    s_add_u32 s6, s6, s4
    s_mul_i32 s6, s6, 28672
    s_mul_i32 s7, s5, 7168
    s_add_u32 s11, s6, s7
    s_add_u32 s11, s11, 65536
    s_add_u32 s24, s11, 4096
    s_add_u32 s25, s11, 14336
    s_add_u32 s26, s25, 4096
    v_lshlrev_b32 v9, 4, v1
    v_and_b32 v10, 3, v1
    v_lshlrev_b32 v10, 4, v10
    v_lshrrev_b32 v124, 4, v1
    v_lshlrev_b32 v124, 8, v124
    v_lshlrev_b32 v10, 2, v10
    v_add_u32 v124, v124, v10
    s_lshl_b32 s9, s3, 10
    v_add_u32 v124, s9, v124
    v_add_u32 v124, 124928, v124
    v_mul_u32_u24 v112, 1366, v0
    v_lshrrev_b32 v112, 16, v112
    v_mul_u32_u24 v113, 48, v112
    v_sub_u32 v113, v0, v113
    v_mul_u32_u24 v114, 5462, v113
    v_lshrrev_b32 v114, 16, v114
    v_mul_u32_u24 v115, 12, v114
    v_sub_u32 v115, v113, v115
    v_lshlrev_b32 v112, 11, v112
    v_lshlrev_b32 v114, 6, v114
    v_add_u32 v112, v112, v114
    v_add_u32 v125, 124928, v112
    v_lshlrev_b32 v115, 2, v115
    v_add_u32 v126, v125, v115
    v_lshlrev_b32 v127, 1, v0
    v_add_u32 v127, 133120, v127
    v_lshlrev_b32 v128, 4, v2
    v_add_u32 v128, 133120, v128
    s_mov_b32 s13, 0
    s_mov_b32 s28, 1
    s_lshl_b32 s29, s89, 16
    s_or_b32 s29, s29, s89
    s_mov_b32 s30, 0x07060302
    s_mov_b32 s10, 0x05040100
    s_mov_b32 s22, 0x000f000f
    s_mov_b32 s23, 0x000f000f
    s_mov_b32 s16, 0x11111111
    s_mov_b32 s17, 0x11111111
    s_waitcnt vmcnt(0)
    v_lshlrev_b32 v176, 16, v176
    v_lshlrev_b32 v177, 16, v177
    s_barrier
    s_cmp_ge_u32 s3, 6
    s_cbranch_scc1 L_r_init

    ds_read_b64_tr_b16 v[180:181], v7 offset:0
    ds_read_b64_tr_b16 v[182:183], v7 offset:1536
    ds_read_b64_tr_b16 v[184:185], v7 offset:12288
    ds_read_b64_tr_b16 v[186:187], v7 offset:13824
    ds_read_b64_tr_b16 v[188:189], v7 offset:24576
    ds_read_b64_tr_b16 v[190:191], v7 offset:26112
    ds_read_b64_tr_b16 v[192:193], v7 offset:36864
    ds_read_b64_tr_b16 v[194:195], v7 offset:38400
    ds_read_b64_tr_b16 v[196:197], v7 offset:49152
    ds_read_b64_tr_b16 v[198:199], v7 offset:50688
    ds_read_b64_tr_b16 v[200:201], v7 offset:61440
    ds_read_b64_tr_b16 v[202:203], v7 offset:62976
    s_waitcnt lgkmcnt(0)
    ds_read_b64_tr_b16 v[204:205], v7 offset:32
    ds_read_b64_tr_b16 v[206:207], v7 offset:1568
    ds_read_b64_tr_b16 v[208:209], v7 offset:12320
    ds_read_b64_tr_b16 v[210:211], v7 offset:13856
    ds_read_b64_tr_b16 v[212:213], v7 offset:24608
    ds_read_b64_tr_b16 v[214:215], v7 offset:26144
    ds_read_b64_tr_b16 v[216:217], v7 offset:36896
    ds_read_b64_tr_b16 v[218:219], v7 offset:38432
    ds_read_b64_tr_b16 v[220:221], v7 offset:49184
    ds_read_b64_tr_b16 v[222:223], v7 offset:50720
    ds_read_b64_tr_b16 v[224:225], v7 offset:61472
    ds_read_b64_tr_b16 v[226:227], v7 offset:63008
    s_waitcnt lgkmcnt(0)
    s_branch L_r_init
L_r_light:
    buffer_load_dwordx4 v[16:19], v9, s[56:59], s11 offen offset:0 sc1
    buffer_load_dwordx4 v[20:23], v9, s[56:59], s25 offen offset:0 sc1
    s_waitcnt vmcnt(0)
    v_perm_b32 v116, v19, v23, s10
    v_cmp_ne_u32 vcc, s29, v116
    s_mov_b32 s31, 126
    s_cbranch_vccz L_r_reload
    s_sleep 1
    s_add_u32 s13, s13, 1
    s_cmp_lt_u32 s13, 0x10000
    s_cbranch_scc1 L_r_light
    s_branch L_r_reload
L_r_probe:
    s_mov_b32 s31, s12
L_r_reload:

    s_bitcmp1_b32 s31, 0
    s_cselect_b64 exec, -1, 1
    buffer_load_dwordx4 v[16:19], v9, s[56:59], s11 offen offset:0 sc1
    buffer_load_dwordx4 v[20:23], v9, s[56:59], s25 offen offset:0 sc1
    s_bitcmp1_b32 s31, 1
    s_cselect_b64 exec, -1, 1
    buffer_load_dwordx4 v[24:27], v9, s[56:59], s11 offen offset:1024 sc1
    buffer_load_dwordx4 v[28:31], v9, s[56:59], s25 offen offset:1024 sc1
    s_bitcmp1_b32 s31, 2
    s_cselect_b64 exec, -1, 1
    buffer_load_dwordx4 v[32:35], v9, s[56:59], s11 offen offset:2048 sc1
    buffer_load_dwordx4 v[36:39], v9, s[56:59], s25 offen offset:2048 sc1
    s_bitcmp1_b32 s31, 3
    s_cselect_b64 exec, -1, 1
    buffer_load_dwordx4 v[40:43], v9, s[56:59], s11 offen offset:3072 sc1
    buffer_load_dwordx4 v[44:47], v9, s[56:59], s25 offen offset:3072 sc1
    s_bitcmp1_b32 s31, 4
    s_cselect_b64 exec, -1, 1
    buffer_load_dwordx4 v[48:51], v9, s[56:59], s24 offen offset:0 sc1
    buffer_load_dwordx4 v[52:55], v9, s[56:59], s26 offen offset:0 sc1
    s_bitcmp1_b32 s31, 5
    s_cselect_b64 exec, -1, 1
    buffer_load_dwordx4 v[56:59], v9, s[56:59], s24 offen offset:1024 sc1
    buffer_load_dwordx4 v[60:63], v9, s[56:59], s26 offen offset:1024 sc1
    s_bitcmp1_b32 s31, 6
    s_cselect_b64 exec, -1, 1
    buffer_load_dwordx4 v[64:67], v9, s[56:59], s24 offen offset:2048 sc1
    buffer_load_dwordx4 v[68:71], v9, s[56:59], s26 offen offset:2048 sc1
    s_mov_b64 exec, -1
    s_branch L_r_proc
L_r_init:
    v_mov_b32 v101, 0
    v_mov_b32 v100, 0

    v_mov_b32 v102, 0
    v_mov_b32 v103, 0
    v_mov_b32 v104, 0
    v_mov_b32 v105, 0
    v_mov_b32 v106, 0
    v_mov_b32 v107, 0
    v_mov_b32 v108, 0
    v_mov_b32 v109, 0
    v_mov_b32 v110, 0
    v_mov_b32 v111, 0
    v_mov_b32 v112, 0
    v_mov_b32 v113, 0
    s_mov_b32 s12, 127
    s_mov_b32 s9, 0
    s_mov_b32 s31, 127
    s_cmp_eq_u32 s28, 1
    s_cbranch_scc0 L_r_light
L_r_proc:

    s_waitcnt vmcnt(12)
    s_bitcmp1_b32 s12, 0
    s_cbranch_scc0 L_r_nx_0
    v_perm_b32 v116, v19, v23, s10
    v_perm_b32 v72, v19, v23, s30
    v_cmp_ne_u32 vcc, s29, v116
    s_cbranch_vccz L_r_ok_0
    s_cmp_eq_u32 s28, 1
    s_cbranch_scc0 L_r_nx_0
L_r_ok_0:
    s_bitset0_b32 s12, 0
    s_cmp_lg_u32 s9, 0
    s_cbranch_scc1 L_r_hm_0
    v_mov_b32 v100, v72
    s_nop 1
    v_max_f32_dpp v100, v100, v100 row_ror:8 row_mask:0xf bank_mask:0xf
    s_nop 1
    v_max_f32_dpp v100, v100, v100 row_ror:4 row_mask:0xf bank_mask:0xf
    v_mov_b32 v116, v100
    s_nop 1
    v_permlane16_swap_b32 v116, v100
    v_max_f32 v100, v100, v116
    v_mov_b32 v116, v100
    s_nop 1
    v_permlane32_swap_b32 v116, v100
    v_max_f32 v100, v100, v116
    s_mov_b32 s9, 1
L_r_hm_0:
    v_sub_f32 v72, v72, v100

    v_cmp_lt_f32 vcc, 0x42800000, v72
    v_lshlrev_b32 v116, 16, v16
    v_and_b32 v117, 0xffff0000, v16
    v_lshlrev_b32 v118, 16, v17
    v_and_b32 v119, 0xffff0000, v17
    v_lshlrev_b32 v120, 16, v18
    v_and_b32 v121, 0xffff0000, v18
    s_cbranch_vccnz L_r_resc_0
L_r_cont_0:
    v_exp_f32 v72, v72
    s_nop 0
    v_pk_fma_f32 v[102:103], v[116:117], v[72:73], v[102:103] op_sel_hi:[1,0,1]
    v_pk_fma_f32 v[104:105], v[118:119], v[72:73], v[104:105] op_sel_hi:[1,0,1]
    v_add_f32 v101, v101, v72
    v_pk_fma_f32 v[106:107], v[120:121], v[72:73], v[106:107] op_sel_hi:[1,0,1]
    v_lshlrev_b32 v116, 16, v20
    v_and_b32 v117, 0xffff0000, v20
    v_pk_fma_f32 v[108:109], v[116:117], v[72:73], v[108:109] op_sel_hi:[1,0,1]
    v_lshlrev_b32 v118, 16, v21
    v_and_b32 v119, 0xffff0000, v21
    v_pk_fma_f32 v[110:111], v[118:119], v[72:73], v[110:111] op_sel_hi:[1,0,1]
    v_lshlrev_b32 v120, 16, v22
    v_and_b32 v121, 0xffff0000, v22
    v_pk_fma_f32 v[112:113], v[120:121], v[72:73], v[112:113] op_sel_hi:[1,0,1]
L_r_nx_0:
    s_waitcnt vmcnt(10)
    s_bitcmp1_b32 s12, 1
    s_cbranch_scc0 L_r_nx_1
    v_perm_b32 v116, v27, v31, s10
    v_perm_b32 v73, v27, v31, s30
    v_cmp_ne_u32 vcc, s29, v116
    s_cbranch_vccz L_r_ok_1
    s_cmp_eq_u32 s28, 1
    s_cbranch_scc0 L_r_nx_1
L_r_ok_1:
    s_bitset0_b32 s12, 1
    s_cmp_lg_u32 s9, 0
    s_cbranch_scc1 L_r_hm_1
    v_mov_b32 v100, v73
    s_nop 1
    v_max_f32_dpp v100, v100, v100 row_ror:8 row_mask:0xf bank_mask:0xf
    s_nop 1
    v_max_f32_dpp v100, v100, v100 row_ror:4 row_mask:0xf bank_mask:0xf
    v_mov_b32 v116, v100
    s_nop 1
    v_permlane16_swap_b32 v116, v100
    v_max_f32 v100, v100, v116
    v_mov_b32 v116, v100
    s_nop 1
    v_permlane32_swap_b32 v116, v100
    v_max_f32 v100, v100, v116
    s_mov_b32 s9, 1
L_r_hm_1:
    v_sub_f32 v73, v73, v100

    v_cmp_lt_f32 vcc, 0x42800000, v73
    v_lshlrev_b32 v116, 16, v24
    v_and_b32 v117, 0xffff0000, v24
    v_lshlrev_b32 v118, 16, v25
    v_and_b32 v119, 0xffff0000, v25
    v_lshlrev_b32 v120, 16, v26
    v_and_b32 v121, 0xffff0000, v26
    s_cbranch_vccnz L_r_resc_1
L_r_cont_1:
    v_exp_f32 v73, v73
    s_nop 0
    v_pk_fma_f32 v[102:103], v[116:117], v[72:73], v[102:103] op_sel:[0,1,0] op_sel_hi:[1,1,1]
    v_pk_fma_f32 v[104:105], v[118:119], v[72:73], v[104:105] op_sel:[0,1,0] op_sel_hi:[1,1,1]
    v_add_f32 v101, v101, v73
    v_pk_fma_f32 v[106:107], v[120:121], v[72:73], v[106:107] op_sel:[0,1,0] op_sel_hi:[1,1,1]
    v_lshlrev_b32 v116, 16, v28
    v_and_b32 v117, 0xffff0000, v28
    v_pk_fma_f32 v[108:109], v[116:117], v[72:73], v[108:109] op_sel:[0,1,0] op_sel_hi:[1,1,1]
    v_lshlrev_b32 v118, 16, v29
    v_and_b32 v119, 0xffff0000, v29
    v_pk_fma_f32 v[110:111], v[118:119], v[72:73], v[110:111] op_sel:[0,1,0] op_sel_hi:[1,1,1]
    v_lshlrev_b32 v120, 16, v30
    v_and_b32 v121, 0xffff0000, v30
    v_pk_fma_f32 v[112:113], v[120:121], v[72:73], v[112:113] op_sel:[0,1,0] op_sel_hi:[1,1,1]
L_r_nx_1:
    s_waitcnt vmcnt(8)
    s_bitcmp1_b32 s12, 2
    s_cbranch_scc0 L_r_nx_2
    v_perm_b32 v116, v35, v39, s10
    v_perm_b32 v74, v35, v39, s30
    v_cmp_ne_u32 vcc, s29, v116
    s_cbranch_vccz L_r_ok_2
    s_cmp_eq_u32 s28, 1
    s_cbranch_scc0 L_r_nx_2
L_r_ok_2:
    s_bitset0_b32 s12, 2
    s_cmp_lg_u32 s9, 0
    s_cbranch_scc1 L_r_hm_2
    v_mov_b32 v100, v74
    s_nop 1
    v_max_f32_dpp v100, v100, v100 row_ror:8 row_mask:0xf bank_mask:0xf
    s_nop 1
    v_max_f32_dpp v100, v100, v100 row_ror:4 row_mask:0xf bank_mask:0xf
    v_mov_b32 v116, v100
    s_nop 1
    v_permlane16_swap_b32 v116, v100
    v_max_f32 v100, v100, v116
    v_mov_b32 v116, v100
    s_nop 1
    v_permlane32_swap_b32 v116, v100
    v_max_f32 v100, v100, v116
    s_mov_b32 s9, 1
L_r_hm_2:
    v_sub_f32 v74, v74, v100

    v_cmp_lt_f32 vcc, 0x42800000, v74
    v_lshlrev_b32 v116, 16, v32
    v_and_b32 v117, 0xffff0000, v32
    v_lshlrev_b32 v118, 16, v33
    v_and_b32 v119, 0xffff0000, v33
    v_lshlrev_b32 v120, 16, v34
    v_and_b32 v121, 0xffff0000, v34
    s_cbranch_vccnz L_r_resc_2
L_r_cont_2:
    v_exp_f32 v74, v74
    s_nop 0
    v_pk_fma_f32 v[102:103], v[116:117], v[74:75], v[102:103] op_sel_hi:[1,0,1]
    v_pk_fma_f32 v[104:105], v[118:119], v[74:75], v[104:105] op_sel_hi:[1,0,1]
    v_add_f32 v101, v101, v74
    v_pk_fma_f32 v[106:107], v[120:121], v[74:75], v[106:107] op_sel_hi:[1,0,1]
    v_lshlrev_b32 v116, 16, v36
    v_and_b32 v117, 0xffff0000, v36
    v_pk_fma_f32 v[108:109], v[116:117], v[74:75], v[108:109] op_sel_hi:[1,0,1]
    v_lshlrev_b32 v118, 16, v37
    v_and_b32 v119, 0xffff0000, v37
    v_pk_fma_f32 v[110:111], v[118:119], v[74:75], v[110:111] op_sel_hi:[1,0,1]
    v_lshlrev_b32 v120, 16, v38
    v_and_b32 v121, 0xffff0000, v38
    v_pk_fma_f32 v[112:113], v[120:121], v[74:75], v[112:113] op_sel_hi:[1,0,1]
L_r_nx_2:
    s_waitcnt vmcnt(6)
    s_bitcmp1_b32 s12, 3
    s_cbranch_scc0 L_r_nx_3
    v_perm_b32 v116, v43, v47, s10
    v_perm_b32 v75, v43, v47, s30
    v_cmp_ne_u32 vcc, s29, v116
    s_cbranch_vccz L_r_ok_3
    s_cmp_eq_u32 s28, 1
    s_cbranch_scc0 L_r_nx_3
L_r_ok_3:
    s_bitset0_b32 s12, 3
    s_cmp_lg_u32 s9, 0
    s_cbranch_scc1 L_r_hm_3
    v_mov_b32 v100, v75
    s_nop 1
    v_max_f32_dpp v100, v100, v100 row_ror:8 row_mask:0xf bank_mask:0xf
    s_nop 1
    v_max_f32_dpp v100, v100, v100 row_ror:4 row_mask:0xf bank_mask:0xf
    v_mov_b32 v116, v100
    s_nop 1
    v_permlane16_swap_b32 v116, v100
    v_max_f32 v100, v100, v116
    v_mov_b32 v116, v100
    s_nop 1
    v_permlane32_swap_b32 v116, v100
    v_max_f32 v100, v100, v116
    s_mov_b32 s9, 1
L_r_hm_3:
    v_sub_f32 v75, v75, v100

    v_cmp_lt_f32 vcc, 0x42800000, v75
    v_lshlrev_b32 v116, 16, v40
    v_and_b32 v117, 0xffff0000, v40
    v_lshlrev_b32 v118, 16, v41
    v_and_b32 v119, 0xffff0000, v41
    v_lshlrev_b32 v120, 16, v42
    v_and_b32 v121, 0xffff0000, v42
    s_cbranch_vccnz L_r_resc_3
L_r_cont_3:
    v_exp_f32 v75, v75
    s_nop 0
    v_pk_fma_f32 v[102:103], v[116:117], v[74:75], v[102:103] op_sel:[0,1,0] op_sel_hi:[1,1,1]
    v_pk_fma_f32 v[104:105], v[118:119], v[74:75], v[104:105] op_sel:[0,1,0] op_sel_hi:[1,1,1]
    v_add_f32 v101, v101, v75
    v_pk_fma_f32 v[106:107], v[120:121], v[74:75], v[106:107] op_sel:[0,1,0] op_sel_hi:[1,1,1]
    v_lshlrev_b32 v116, 16, v44
    v_and_b32 v117, 0xffff0000, v44
    v_pk_fma_f32 v[108:109], v[116:117], v[74:75], v[108:109] op_sel:[0,1,0] op_sel_hi:[1,1,1]
    v_lshlrev_b32 v118, 16, v45
    v_and_b32 v119, 0xffff0000, v45
    v_pk_fma_f32 v[110:111], v[118:119], v[74:75], v[110:111] op_sel:[0,1,0] op_sel_hi:[1,1,1]
    v_lshlrev_b32 v120, 16, v46
    v_and_b32 v121, 0xffff0000, v46
    v_pk_fma_f32 v[112:113], v[120:121], v[74:75], v[112:113] op_sel:[0,1,0] op_sel_hi:[1,1,1]
L_r_nx_3:
    s_waitcnt vmcnt(4)
    s_bitcmp1_b32 s12, 4
    s_cbranch_scc0 L_r_nx_4
    v_perm_b32 v116, v51, v55, s10
    v_perm_b32 v76, v51, v55, s30
    v_cmp_ne_u32 vcc, s29, v116
    s_cbranch_vccz L_r_ok_4
    s_cmp_eq_u32 s28, 1
    s_cbranch_scc0 L_r_nx_4
L_r_ok_4:
    s_bitset0_b32 s12, 4
    s_cmp_lg_u32 s9, 0
    s_cbranch_scc1 L_r_hm_4
    v_mov_b32 v100, v76
    s_nop 1
    v_max_f32_dpp v100, v100, v100 row_ror:8 row_mask:0xf bank_mask:0xf
    s_nop 1
    v_max_f32_dpp v100, v100, v100 row_ror:4 row_mask:0xf bank_mask:0xf
    v_mov_b32 v116, v100
    s_nop 1
    v_permlane16_swap_b32 v116, v100
    v_max_f32 v100, v100, v116
    v_mov_b32 v116, v100
    s_nop 1
    v_permlane32_swap_b32 v116, v100
    v_max_f32 v100, v100, v116
    s_mov_b32 s9, 1
L_r_hm_4:
    v_sub_f32 v76, v76, v100

    v_cmp_lt_f32 vcc, 0x42800000, v76
    v_lshlrev_b32 v116, 16, v48
    v_and_b32 v117, 0xffff0000, v48
    v_lshlrev_b32 v118, 16, v49
    v_and_b32 v119, 0xffff0000, v49
    v_lshlrev_b32 v120, 16, v50
    v_and_b32 v121, 0xffff0000, v50
    s_cbranch_vccnz L_r_resc_4
L_r_cont_4:
    v_exp_f32 v76, v76
    s_nop 0
    v_pk_fma_f32 v[102:103], v[116:117], v[76:77], v[102:103] op_sel_hi:[1,0,1]
    v_pk_fma_f32 v[104:105], v[118:119], v[76:77], v[104:105] op_sel_hi:[1,0,1]
    v_add_f32 v101, v101, v76
    v_pk_fma_f32 v[106:107], v[120:121], v[76:77], v[106:107] op_sel_hi:[1,0,1]
    v_lshlrev_b32 v116, 16, v52
    v_and_b32 v117, 0xffff0000, v52
    v_pk_fma_f32 v[108:109], v[116:117], v[76:77], v[108:109] op_sel_hi:[1,0,1]
    v_lshlrev_b32 v118, 16, v53
    v_and_b32 v119, 0xffff0000, v53
    v_pk_fma_f32 v[110:111], v[118:119], v[76:77], v[110:111] op_sel_hi:[1,0,1]
    v_lshlrev_b32 v120, 16, v54
    v_and_b32 v121, 0xffff0000, v54
    v_pk_fma_f32 v[112:113], v[120:121], v[76:77], v[112:113] op_sel_hi:[1,0,1]
L_r_nx_4:
    s_waitcnt vmcnt(2)
    s_bitcmp1_b32 s12, 5
    s_cbranch_scc0 L_r_nx_5
    v_perm_b32 v116, v59, v63, s10
    v_perm_b32 v77, v59, v63, s30
    v_cmp_ne_u32 vcc, s29, v116
    s_cbranch_vccz L_r_ok_5
    s_cmp_eq_u32 s28, 1
    s_cbranch_scc0 L_r_nx_5
L_r_ok_5:
    s_bitset0_b32 s12, 5
    s_cmp_lg_u32 s9, 0
    s_cbranch_scc1 L_r_hm_5
    v_mov_b32 v100, v77
    s_nop 1
    v_max_f32_dpp v100, v100, v100 row_ror:8 row_mask:0xf bank_mask:0xf
    s_nop 1
    v_max_f32_dpp v100, v100, v100 row_ror:4 row_mask:0xf bank_mask:0xf
    v_mov_b32 v116, v100
    s_nop 1
    v_permlane16_swap_b32 v116, v100
    v_max_f32 v100, v100, v116
    v_mov_b32 v116, v100
    s_nop 1
    v_permlane32_swap_b32 v116, v100
    v_max_f32 v100, v100, v116
    s_mov_b32 s9, 1
L_r_hm_5:
    v_sub_f32 v77, v77, v100

    v_cmp_lt_f32 vcc, 0x42800000, v77
    v_lshlrev_b32 v116, 16, v56
    v_and_b32 v117, 0xffff0000, v56
    v_lshlrev_b32 v118, 16, v57
    v_and_b32 v119, 0xffff0000, v57
    v_lshlrev_b32 v120, 16, v58
    v_and_b32 v121, 0xffff0000, v58
    s_cbranch_vccnz L_r_resc_5
L_r_cont_5:
    v_exp_f32 v77, v77
    s_nop 0
    v_pk_fma_f32 v[102:103], v[116:117], v[76:77], v[102:103] op_sel:[0,1,0] op_sel_hi:[1,1,1]
    v_pk_fma_f32 v[104:105], v[118:119], v[76:77], v[104:105] op_sel:[0,1,0] op_sel_hi:[1,1,1]
    v_add_f32 v101, v101, v77
    v_pk_fma_f32 v[106:107], v[120:121], v[76:77], v[106:107] op_sel:[0,1,0] op_sel_hi:[1,1,1]
    v_lshlrev_b32 v116, 16, v60
    v_and_b32 v117, 0xffff0000, v60
    v_pk_fma_f32 v[108:109], v[116:117], v[76:77], v[108:109] op_sel:[0,1,0] op_sel_hi:[1,1,1]
    v_lshlrev_b32 v118, 16, v61
    v_and_b32 v119, 0xffff0000, v61
    v_pk_fma_f32 v[110:111], v[118:119], v[76:77], v[110:111] op_sel:[0,1,0] op_sel_hi:[1,1,1]
    v_lshlrev_b32 v120, 16, v62
    v_and_b32 v121, 0xffff0000, v62
    v_pk_fma_f32 v[112:113], v[120:121], v[76:77], v[112:113] op_sel:[0,1,0] op_sel_hi:[1,1,1]
L_r_nx_5:
    s_waitcnt vmcnt(0)
    s_bitcmp1_b32 s12, 6
    s_cbranch_scc0 L_r_nx_6
    v_perm_b32 v116, v67, v71, s10
    v_perm_b32 v78, v67, v71, s30
    v_cmp_ne_u32 vcc, s29, v116
    s_cbranch_vccz L_r_ok_6
    s_cmp_eq_u32 s28, 1
    s_cbranch_scc0 L_r_nx_6
L_r_ok_6:
    s_bitset0_b32 s12, 6
    s_cmp_lg_u32 s9, 0
    s_cbranch_scc1 L_r_hm_6
    v_mov_b32 v100, v78
    s_nop 1
    v_max_f32_dpp v100, v100, v100 row_ror:8 row_mask:0xf bank_mask:0xf
    s_nop 1
    v_max_f32_dpp v100, v100, v100 row_ror:4 row_mask:0xf bank_mask:0xf
    v_mov_b32 v116, v100
    s_nop 1
    v_permlane16_swap_b32 v116, v100
    v_max_f32 v100, v100, v116
    v_mov_b32 v116, v100
    s_nop 1
    v_permlane32_swap_b32 v116, v100
    v_max_f32 v100, v100, v116
    s_mov_b32 s9, 1
L_r_hm_6:
    v_sub_f32 v78, v78, v100

    v_cmp_lt_f32 vcc, 0x42800000, v78
    v_lshlrev_b32 v116, 16, v64
    v_and_b32 v117, 0xffff0000, v64
    v_lshlrev_b32 v118, 16, v65
    v_and_b32 v119, 0xffff0000, v65
    v_lshlrev_b32 v120, 16, v66
    v_and_b32 v121, 0xffff0000, v66
    s_cbranch_vccnz L_r_resc_6
L_r_cont_6:
    v_exp_f32 v78, v78
    s_nop 0
    v_pk_fma_f32 v[102:103], v[116:117], v[78:79], v[102:103] op_sel_hi:[1,0,1]
    v_pk_fma_f32 v[104:105], v[118:119], v[78:79], v[104:105] op_sel_hi:[1,0,1]
    v_add_f32 v101, v101, v78
    v_pk_fma_f32 v[106:107], v[120:121], v[78:79], v[106:107] op_sel_hi:[1,0,1]
    v_lshlrev_b32 v116, 16, v68
    v_and_b32 v117, 0xffff0000, v68
    v_pk_fma_f32 v[108:109], v[116:117], v[78:79], v[108:109] op_sel_hi:[1,0,1]
    v_lshlrev_b32 v118, 16, v69
    v_and_b32 v119, 0xffff0000, v69
    v_pk_fma_f32 v[110:111], v[118:119], v[78:79], v[110:111] op_sel_hi:[1,0,1]
    v_lshlrev_b32 v120, 16, v70
    v_and_b32 v121, 0xffff0000, v70
    v_pk_fma_f32 v[112:113], v[120:121], v[78:79], v[112:113] op_sel_hi:[1,0,1]
L_r_nx_6:
    s_cmp_eq_u32 s12, 0
    s_cbranch_scc1 L_r_merge
    s_branch L_r_retry

L_r_resc_0:
    v_max_f32 v122, 0, v72
    s_nop 1
    v_max_f32_dpp v122, v122, v122 row_ror:8 row_mask:0xf bank_mask:0xf
    s_nop 1
    v_max_f32_dpp v122, v122, v122 row_ror:4 row_mask:0xf bank_mask:0xf
    v_mov_b32 v123, v122
    s_nop 1
    v_permlane16_swap_b32 v123, v122
    v_max_f32 v122, v122, v123
    v_mov_b32 v123, v122
    s_nop 1
    v_permlane32_swap_b32 v123, v122
    v_max_f32 v122, v122, v123
    v_add_f32 v100, v100, v122
    v_sub_f32 v72, v72, v122
    v_sub_f32 v122, 0, v122
    v_exp_f32 v122, v122
    s_nop 0
    v_mul_f32 v101, v101, v122

    v_mul_f32 v102, v102, v122
    v_mul_f32 v103, v103, v122
    v_mul_f32 v104, v104, v122
    v_mul_f32 v105, v105, v122
    v_mul_f32 v106, v106, v122
    v_mul_f32 v107, v107, v122
    v_mul_f32 v108, v108, v122
    v_mul_f32 v109, v109, v122
    v_mul_f32 v110, v110, v122
    v_mul_f32 v111, v111, v122
    v_mul_f32 v112, v112, v122
    v_mul_f32 v113, v113, v122
    s_branch L_r_cont_0
L_r_resc_1:
    v_max_f32 v122, 0, v73
    s_nop 1
    v_max_f32_dpp v122, v122, v122 row_ror:8 row_mask:0xf bank_mask:0xf
    s_nop 1
    v_max_f32_dpp v122, v122, v122 row_ror:4 row_mask:0xf bank_mask:0xf
    v_mov_b32 v123, v122
    s_nop 1
    v_permlane16_swap_b32 v123, v122
    v_max_f32 v122, v122, v123
    v_mov_b32 v123, v122
    s_nop 1
    v_permlane32_swap_b32 v123, v122
    v_max_f32 v122, v122, v123
    v_add_f32 v100, v100, v122
    v_sub_f32 v73, v73, v122
    v_sub_f32 v122, 0, v122
    v_exp_f32 v122, v122
    s_nop 0
    v_mul_f32 v101, v101, v122

    v_mul_f32 v102, v102, v122
    v_mul_f32 v103, v103, v122
    v_mul_f32 v104, v104, v122
    v_mul_f32 v105, v105, v122
    v_mul_f32 v106, v106, v122
    v_mul_f32 v107, v107, v122
    v_mul_f32 v108, v108, v122
    v_mul_f32 v109, v109, v122
    v_mul_f32 v110, v110, v122
    v_mul_f32 v111, v111, v122
    v_mul_f32 v112, v112, v122
    v_mul_f32 v113, v113, v122
    s_branch L_r_cont_1
L_r_resc_2:
    v_max_f32 v122, 0, v74
    s_nop 1
    v_max_f32_dpp v122, v122, v122 row_ror:8 row_mask:0xf bank_mask:0xf
    s_nop 1
    v_max_f32_dpp v122, v122, v122 row_ror:4 row_mask:0xf bank_mask:0xf
    v_mov_b32 v123, v122
    s_nop 1
    v_permlane16_swap_b32 v123, v122
    v_max_f32 v122, v122, v123
    v_mov_b32 v123, v122
    s_nop 1
    v_permlane32_swap_b32 v123, v122
    v_max_f32 v122, v122, v123
    v_add_f32 v100, v100, v122
    v_sub_f32 v74, v74, v122
    v_sub_f32 v122, 0, v122
    v_exp_f32 v122, v122
    s_nop 0
    v_mul_f32 v101, v101, v122

    v_mul_f32 v102, v102, v122
    v_mul_f32 v103, v103, v122
    v_mul_f32 v104, v104, v122
    v_mul_f32 v105, v105, v122
    v_mul_f32 v106, v106, v122
    v_mul_f32 v107, v107, v122
    v_mul_f32 v108, v108, v122
    v_mul_f32 v109, v109, v122
    v_mul_f32 v110, v110, v122
    v_mul_f32 v111, v111, v122
    v_mul_f32 v112, v112, v122
    v_mul_f32 v113, v113, v122
    s_branch L_r_cont_2
L_r_resc_3:
    v_max_f32 v122, 0, v75
    s_nop 1
    v_max_f32_dpp v122, v122, v122 row_ror:8 row_mask:0xf bank_mask:0xf
    s_nop 1
    v_max_f32_dpp v122, v122, v122 row_ror:4 row_mask:0xf bank_mask:0xf
    v_mov_b32 v123, v122
    s_nop 1
    v_permlane16_swap_b32 v123, v122
    v_max_f32 v122, v122, v123
    v_mov_b32 v123, v122
    s_nop 1
    v_permlane32_swap_b32 v123, v122
    v_max_f32 v122, v122, v123
    v_add_f32 v100, v100, v122
    v_sub_f32 v75, v75, v122
    v_sub_f32 v122, 0, v122
    v_exp_f32 v122, v122
    s_nop 0
    v_mul_f32 v101, v101, v122

    v_mul_f32 v102, v102, v122
    v_mul_f32 v103, v103, v122
    v_mul_f32 v104, v104, v122
    v_mul_f32 v105, v105, v122
    v_mul_f32 v106, v106, v122
    v_mul_f32 v107, v107, v122
    v_mul_f32 v108, v108, v122
    v_mul_f32 v109, v109, v122
    v_mul_f32 v110, v110, v122
    v_mul_f32 v111, v111, v122
    v_mul_f32 v112, v112, v122
    v_mul_f32 v113, v113, v122
    s_branch L_r_cont_3
L_r_resc_4:
    v_max_f32 v122, 0, v76
    s_nop 1
    v_max_f32_dpp v122, v122, v122 row_ror:8 row_mask:0xf bank_mask:0xf
    s_nop 1
    v_max_f32_dpp v122, v122, v122 row_ror:4 row_mask:0xf bank_mask:0xf
    v_mov_b32 v123, v122
    s_nop 1
    v_permlane16_swap_b32 v123, v122
    v_max_f32 v122, v122, v123
    v_mov_b32 v123, v122
    s_nop 1
    v_permlane32_swap_b32 v123, v122
    v_max_f32 v122, v122, v123
    v_add_f32 v100, v100, v122
    v_sub_f32 v76, v76, v122
    v_sub_f32 v122, 0, v122
    v_exp_f32 v122, v122
    s_nop 0
    v_mul_f32 v101, v101, v122

    v_mul_f32 v102, v102, v122
    v_mul_f32 v103, v103, v122
    v_mul_f32 v104, v104, v122
    v_mul_f32 v105, v105, v122
    v_mul_f32 v106, v106, v122
    v_mul_f32 v107, v107, v122
    v_mul_f32 v108, v108, v122
    v_mul_f32 v109, v109, v122
    v_mul_f32 v110, v110, v122
    v_mul_f32 v111, v111, v122
    v_mul_f32 v112, v112, v122
    v_mul_f32 v113, v113, v122
    s_branch L_r_cont_4
L_r_resc_5:
    v_max_f32 v122, 0, v77
    s_nop 1
    v_max_f32_dpp v122, v122, v122 row_ror:8 row_mask:0xf bank_mask:0xf
    s_nop 1
    v_max_f32_dpp v122, v122, v122 row_ror:4 row_mask:0xf bank_mask:0xf
    v_mov_b32 v123, v122
    s_nop 1
    v_permlane16_swap_b32 v123, v122
    v_max_f32 v122, v122, v123
    v_mov_b32 v123, v122
    s_nop 1
    v_permlane32_swap_b32 v123, v122
    v_max_f32 v122, v122, v123
    v_add_f32 v100, v100, v122
    v_sub_f32 v77, v77, v122
    v_sub_f32 v122, 0, v122
    v_exp_f32 v122, v122
    s_nop 0
    v_mul_f32 v101, v101, v122

    v_mul_f32 v102, v102, v122
    v_mul_f32 v103, v103, v122
    v_mul_f32 v104, v104, v122
    v_mul_f32 v105, v105, v122
    v_mul_f32 v106, v106, v122
    v_mul_f32 v107, v107, v122
    v_mul_f32 v108, v108, v122
    v_mul_f32 v109, v109, v122
    v_mul_f32 v110, v110, v122
    v_mul_f32 v111, v111, v122
    v_mul_f32 v112, v112, v122
    v_mul_f32 v113, v113, v122
    s_branch L_r_cont_5
L_r_resc_6:
    v_max_f32 v122, 0, v78
    s_nop 1
    v_max_f32_dpp v122, v122, v122 row_ror:8 row_mask:0xf bank_mask:0xf
    s_nop 1
    v_max_f32_dpp v122, v122, v122 row_ror:4 row_mask:0xf bank_mask:0xf
    v_mov_b32 v123, v122
    s_nop 1
    v_permlane16_swap_b32 v123, v122
    v_max_f32 v122, v122, v123
    v_mov_b32 v123, v122
    s_nop 1
    v_permlane32_swap_b32 v123, v122
    v_max_f32 v122, v122, v123
    v_add_f32 v100, v100, v122
    v_sub_f32 v78, v78, v122
    v_sub_f32 v122, 0, v122
    v_exp_f32 v122, v122
    s_nop 0
    v_mul_f32 v101, v101, v122

    v_mul_f32 v102, v102, v122
    v_mul_f32 v103, v103, v122
    v_mul_f32 v104, v104, v122
    v_mul_f32 v105, v105, v122
    v_mul_f32 v106, v106, v122
    v_mul_f32 v107, v107, v122
    v_mul_f32 v108, v108, v122
    v_mul_f32 v109, v109, v122
    v_mul_f32 v110, v110, v122
    v_mul_f32 v111, v111, v122
    v_mul_f32 v112, v112, v122
    v_mul_f32 v113, v113, v122
    s_branch L_r_cont_6
L_r_retry:
    s_add_u32 s13, s13, 1
    s_cmp_lt_u32 s13, 0x10000
    s_cbranch_scc1 L_r_probe
L_r_merge:

    v_add_f32_dpp v102, v102, v102 row_ror:8 row_mask:0xf bank_mask:0xf
    v_add_f32_dpp v103, v103, v103 row_ror:8 row_mask:0xf bank_mask:0xf
    v_add_f32_dpp v104, v104, v104 row_ror:8 row_mask:0xf bank_mask:0xf
    v_add_f32_dpp v105, v105, v105 row_ror:8 row_mask:0xf bank_mask:0xf
    v_add_f32_dpp v106, v106, v106 row_ror:8 row_mask:0xf bank_mask:0xf
    v_add_f32_dpp v107, v107, v107 row_ror:8 row_mask:0xf bank_mask:0xf
    v_add_f32_dpp v108, v108, v108 row_ror:8 row_mask:0xf bank_mask:0xf
    v_add_f32_dpp v109, v109, v109 row_ror:8 row_mask:0xf bank_mask:0xf
    v_add_f32_dpp v110, v110, v110 row_ror:8 row_mask:0xf bank_mask:0xf
    v_add_f32_dpp v111, v111, v111 row_ror:8 row_mask:0xf bank_mask:0xf
    v_add_f32_dpp v112, v112, v112 row_ror:8 row_mask:0xf bank_mask:0xf
    v_add_f32_dpp v113, v113, v113 row_ror:8 row_mask:0xf bank_mask:0xf
    v_add_f32_dpp v101, v101, v101 row_ror:8 row_mask:0xf bank_mask:0xf
    v_add_f32_dpp v102, v102, v102 row_ror:4 row_mask:0xf bank_mask:0xf
    v_add_f32_dpp v103, v103, v103 row_ror:4 row_mask:0xf bank_mask:0xf
    v_add_f32_dpp v104, v104, v104 row_ror:4 row_mask:0xf bank_mask:0xf
    v_add_f32_dpp v105, v105, v105 row_ror:4 row_mask:0xf bank_mask:0xf
    v_add_f32_dpp v106, v106, v106 row_ror:4 row_mask:0xf bank_mask:0xf
    v_add_f32_dpp v107, v107, v107 row_ror:4 row_mask:0xf bank_mask:0xf
    v_add_f32_dpp v108, v108, v108 row_ror:4 row_mask:0xf bank_mask:0xf
    v_add_f32_dpp v109, v109, v109 row_ror:4 row_mask:0xf bank_mask:0xf
    v_add_f32_dpp v110, v110, v110 row_ror:4 row_mask:0xf bank_mask:0xf
    v_add_f32_dpp v111, v111, v111 row_ror:4 row_mask:0xf bank_mask:0xf
    v_add_f32_dpp v112, v112, v112 row_ror:4 row_mask:0xf bank_mask:0xf
    v_add_f32_dpp v113, v113, v113 row_ror:4 row_mask:0xf bank_mask:0xf
    v_add_f32_dpp v101, v101, v101 row_ror:4 row_mask:0xf bank_mask:0xf
    v_mov_b32 v114, v101
    v_mov_b32 v115, v100
    s_mov_b64 exec, s[22:23]
    ds_write_b128 v124, v[102:105]
    ds_write_b128 v124, v[106:109] offset:16
    ds_write_b128 v124, v[110:113] offset:32
    ds_write_b64 v124, v[114:115] offset:48
    s_mov_b64 exec, -1
    s_waitcnt lgkmcnt(0)
    s_barrier
    s_cmp_ge_u32 s3, 3
    s_cbranch_scc1 L_r_b3

    ds_read_b64 v[16:17], v125 offset:48
    ds_read_b64 v[18:19], v125 offset:304
    ds_read_b64 v[20:21], v125 offset:560
    ds_read_b64 v[22:23], v125 offset:816
    ds_read_b64 v[24:25], v125 offset:1072
    ds_read_b64 v[26:27], v125 offset:1328
    ds_read_b64 v[28:29], v125 offset:1584
    ds_read_b64 v[30:31], v125 offset:1840
    ds_read_b32 v32, v126 offset:0
    ds_read_b32 v33, v126 offset:256
    ds_read_b32 v34, v126 offset:512
    ds_read_b32 v35, v126 offset:768
    ds_read_b32 v36, v126 offset:1024
    ds_read_b32 v37, v126 offset:1280
    s_waitcnt lgkmcnt(8)
    ds_read_b32 v38, v126 offset:1536
    ds_read_b32 v39, v126 offset:1792
    s_waitcnt lgkmcnt(8)
    v_max_f32 v40, v17, v25
    v_sub_f32 v41, v17, v40
    v_sub_f32 v42, v25, v40
    v_exp_f32 v41, v41
    v_exp_f32 v42, v42
    v_add_f32 v16, v16, v18
    v_add_f32 v20, v20, v22
    v_add_f32 v24, v24, v26
    v_add_f32 v28, v28, v30
    v_add_f32 v16, v16, v20
    v_add_f32 v24, v24, v28
    v_mul_f32 v16, v16, v41
    v_fmac_f32 v16, v24, v42
    v_rcp_f32 v16, v16
    s_waitcnt lgkmcnt(0)
    v_add_f32 v32, v32, v33
    v_add_f32 v34, v34, v35
    v_add_f32 v36, v36, v37
    v_add_f32 v38, v38, v39
    v_add_f32 v32, v32, v34
    v_add_f32 v36, v36, v38
    v_mul_f32 v32, v32, v41
    v_fmac_f32 v32, v36, v42
    v_mul_f32 v32, v32, v16
    v_cvt_pk_bf16_f32 v32, v32, v32
    ds_write_b16 v127, v32
L_r_b3:
    s_waitcnt lgkmcnt(0)
    s_barrier
    s_cmp_ge_u32 s3, 6
    s_cbranch_scc1 L_r_fin

    ds_read_b128 v[16:19], v128 offset:0
    ds_read_b128 v[20:23], v128 offset:64
    ds_read_b128 v[24:27], v128 offset:128
    ds_read_b128 v[28:31], v128 offset:192
    ds_read_b128 v[32:35], v128 offset:256
    ds_read_b128 v[36:39], v128 offset:320
    s_waitcnt lgkmcnt(5)
    v_mfma_f32_16x16x32_bf16 v[48:51], v[16:19], v[180:183], 0
    v_mfma_f32_16x16x32_bf16 v[52:55], v[16:19], v[204:207], 0
    s_waitcnt lgkmcnt(4)
    v_mfma_f32_16x16x32_bf16 v[56:59], v[20:23], v[184:187], 0
    v_mfma_f32_16x16x32_bf16 v[60:63], v[20:23], v[208:211], 0
    s_waitcnt lgkmcnt(3)
    v_mfma_f32_16x16x32_bf16 v[48:51], v[24:27], v[188:191], v[48:51]
    v_mfma_f32_16x16x32_bf16 v[52:55], v[24:27], v[212:215], v[52:55]
    s_waitcnt lgkmcnt(2)
    v_mfma_f32_16x16x32_bf16 v[56:59], v[28:31], v[192:195], v[56:59]
    v_mfma_f32_16x16x32_bf16 v[60:63], v[28:31], v[216:219], v[60:63]
    s_waitcnt lgkmcnt(1)
    v_mfma_f32_16x16x32_bf16 v[48:51], v[32:35], v[196:199], v[48:51]
    v_mfma_f32_16x16x32_bf16 v[52:55], v[32:35], v[220:223], v[52:55]
    s_waitcnt lgkmcnt(0)
    v_mfma_f32_16x16x32_bf16 v[56:59], v[36:39], v[200:203], v[56:59]
    v_mfma_f32_16x16x32_bf16 v[60:63], v[36:39], v[224:227], v[60:63]
    s_nop 6
    v_add_f32 v48, v48, v56
    v_add_f32 v52, v52, v60
    v_cvt_pk_bf16_f32 v64, v48, v52
    v_lshlrev_b32 v65, 16, v64
    v_and_b32 v66, 0xffff0000, v64
    v_add_f32 v65, v65, v176
    v_add_f32 v66, v66, v177
    v_cvt_pk_bf16_f32 v65, v65, v65
    v_cvt_pk_bf16_f32 v66, v66, v66
    s_cmp_eq_u32 s28, 1
    s_cbranch_scc1 L_r_fin
    s_mov_b64 exec, 0xffff
    buffer_store_short v65, v8, s[84:87], s27 offen
    buffer_store_short v66, v8, s[84:87], s27 offen offset:32
    s_mov_b64 exec, -1
L_r_fin:
    s_cmp_eq_u32 s28, 1
    s_cbranch_scc0 L_r_real_end
    s_mov_b32 s28, 0
    s_barrier

    s_branch L_r_init
L_r_real_end:
    s_cmp_lg_u32 s15, 0
    s_cbranch_scc1 L_r_noep
    s_cmp_lg_u32 s3, 7
    s_cbranch_scc1 L_r_noep
    v_mov_b32 v112, s90
    v_mov_b32 v113, 0
    s_mov_b32 s8, 49152
    s_mov_b64 exec, 1
    buffer_store_dword v112, v113, s[56:59], s8 offen
    s_mov_b64 exec, -1
L_r_noep:

    s_branch L_end
L_worker:
    s_cmp_ge_u32 s3, 4
    s_cbranch_scc1 L_consumer

L_producer:
    v_and_b32 v1, 63, v0
    v_lshrrev_b32 v2, 4, v1
    v_and_b32 v3, 15, v1

    v_add_u32 v20, 0, v1
    v_mul_u32_u24 v21, 2731, v20
    v_lshrrev_b32 v21, 16, v21
    v_mul_u32_u24 v23, 24, v21
    v_sub_u32 v22, v20, v23

    v_lshlrev_b32 v24, 1, v21
    v_and_b32 v24, 4, v24
    v_xor_b32 v25, v22, v24
    v_lshlrev_b32 v25, 4, v25
    v_mul_u32_u24 v26, 384, v21
    v_add_u32 v25, v26, v25
    v_mov_b32 v44, v25
    v_xor_b32 v47, 16, v25
    v_and_b32 v23, 1, v21
    v_or_b32 v23, v23, v24
    v_lshrrev_b32 v24, 1, v21
    v_and_b32 v24, 2, v24
    v_or_b32 v23, v23, v24
    v_xor_b32 v22, v22, v23
    v_lshlrev_b32 v22, 4, v22
    v_add_u32 v10, v26, v22
    v_xor_b32 v13, 16, v10

    v_add_u32 v20, 64, v1
    v_mul_u32_u24 v21, 2731, v20
    v_lshrrev_b32 v21, 16, v21
    v_mul_u32_u24 v23, 24, v21
    v_sub_u32 v22, v20, v23

    v_lshlrev_b32 v24, 1, v21
    v_and_b32 v24, 4, v24
    v_xor_b32 v25, v22, v24
    v_lshlrev_b32 v25, 4, v25
    v_mul_u32_u24 v26, 384, v21
    v_add_u32 v25, v26, v25
    v_mov_b32 v45, v25
    v_xor_b32 v48, 16, v25
    v_and_b32 v23, 1, v21
    v_or_b32 v23, v23, v24
    v_lshrrev_b32 v24, 1, v21
    v_and_b32 v24, 2, v24
    v_or_b32 v23, v23, v24
    v_xor_b32 v22, v22, v23
    v_lshlrev_b32 v22, 4, v22
    v_add_u32 v11, v26, v22
    v_xor_b32 v14, 16, v11

    v_add_u32 v20, 128, v1
    v_mul_u32_u24 v21, 2731, v20
    v_lshrrev_b32 v21, 16, v21
    v_mul_u32_u24 v23, 24, v21
    v_sub_u32 v22, v20, v23

    v_lshlrev_b32 v24, 1, v21
    v_and_b32 v24, 4, v24
    v_xor_b32 v25, v22, v24
    v_lshlrev_b32 v25, 4, v25
    v_mul_u32_u24 v26, 384, v21
    v_add_u32 v25, v26, v25
    v_mov_b32 v46, v25
    v_xor_b32 v49, 16, v25
    v_and_b32 v23, 1, v21
    v_or_b32 v23, v23, v24
    v_lshrrev_b32 v24, 1, v21
    v_and_b32 v24, 2, v24
    v_or_b32 v23, v23, v24
    v_xor_b32 v22, v22, v23
    v_lshlrev_b32 v22, 4, v22
    v_add_u32 v12, v26, v22
    v_xor_b32 v15, 16, v12

    s_lshr_b32 s4, s15, 1
    s_and_b32 s5, s15, 1
    s_mul_i32 s6, s4, 172032
    s_mul_i32 s7, s5, 43008
    s_add_u32 s6, s6, s7
    s_mul_i32 s7, s3, 12288
    s_add_u32 s6, s6, s7
    s_mul_i32 s7, s15, 21504
    s_mul_i32 s8, s3, 6144
    s_add_u32 s7, s7, s8
    s_mov_b32 s14, s8
    s_add_u32 s8, s8, 73728
    s_cmp_eq_u32 s3, 3
    s_cselect_b32 s9, 157696, s8
    s_cselect_b32 s10, 0, 21504
    s_cselect_b32 s12, 1, -1
    s_cselect_b32 s13, 0, -1
    s_waitcnt lgkmcnt(0)

    s_mov_b32 s44, s20
    s_mov_b32 s45, s21
    s_mov_b32 s46, 4816896
    s_mov_b32 s47, 0x00020000
    s_add_u32 m0, s8, 64512
    s_add_u32 s11, s7, 0
    buffer_load_dwordx4 v13, s[44:47], s11 offen nt lds
    s_add_u32 m0, s8, 65536
    s_add_u32 s11, s7, 0
    buffer_load_dwordx4 v14, s[44:47], s11 offen nt lds
    s_add_u32 m0, s8, 66560
    s_add_u32 s11, s7, 0
    buffer_load_dwordx4 v15, s[44:47], s11 offen nt lds
    s_mov_b64 exec, s[12:13]
    s_mul_i32 s92, s10, 3
    s_add_u32 s92, s92, s9
    s_add_u32 m0, s92, 3072
    s_add_u32 s11, s7, 3072
    buffer_load_dwordx4 v10, s[44:47], s11 offen nt lds
    s_add_u32 m0, s92, 4096
    s_add_u32 s11, s7, 3072
    buffer_load_dwordx4 v11, s[44:47], s11 offen nt lds
    s_add_u32 m0, s92, 5120
    s_add_u32 s11, s7, 3072
    buffer_load_dwordx4 v12, s[44:47], s11 offen nt lds
    s_mov_b64 exec, -1
    s_mov_b32 s48, s22
    s_mov_b32 s49, s23
    s_mov_b32 s50, 73728
    s_mov_b32 s51, 0x00020000
    s_add_u32 m0, s14, 0
    s_add_u32 s11, s14, 0
    buffer_load_dwordx4 v44, s[48:51], s11 offen lds

    s_add_u32 m0, s14, 1024
    s_add_u32 s11, s14, 0
    buffer_load_dwordx4 v45, s[48:51], s11 offen lds

    s_add_u32 m0, s14, 2048
    s_add_u32 s11, s14, 0
    buffer_load_dwordx4 v46, s[48:51], s11 offen lds

    s_add_u32 m0, s14, 3072
    s_add_u32 s11, s14, 3072
    buffer_load_dwordx4 v47, s[48:51], s11 offen lds

    s_add_u32 m0, s14, 4096
    s_add_u32 s11, s14, 3072
    buffer_load_dwordx4 v48, s[48:51], s11 offen lds

    s_add_u32 m0, s14, 5120
    s_add_u32 s11, s14, 3072
    buffer_load_dwordx4 v49, s[48:51], s11 offen lds

    s_add_u32 m0, s14, 24576
    s_add_u32 s11, s14, 24576
    buffer_load_dwordx4 v44, s[48:51], s11 offen lds

    s_add_u32 m0, s14, 25600
    s_add_u32 s11, s14, 24576
    buffer_load_dwordx4 v45, s[48:51], s11 offen lds

    s_add_u32 m0, s14, 26624
    s_add_u32 s11, s14, 24576
    buffer_load_dwordx4 v46, s[48:51], s11 offen lds

    s_add_u32 m0, s14, 27648
    s_add_u32 s11, s14, 27648
    buffer_load_dwordx4 v47, s[48:51], s11 offen lds

    s_add_u32 m0, s14, 28672
    s_add_u32 s11, s14, 27648
    buffer_load_dwordx4 v48, s[48:51], s11 offen lds

    s_add_u32 m0, s14, 29696
    s_add_u32 s11, s14, 27648
    buffer_load_dwordx4 v49, s[48:51], s11 offen lds

    s_add_u32 m0, s14, 49152
    s_add_u32 s11, s14, 49152
    buffer_load_dwordx4 v44, s[48:51], s11 offen lds

    s_add_u32 m0, s14, 50176
    s_add_u32 s11, s14, 49152
    buffer_load_dwordx4 v45, s[48:51], s11 offen lds

    s_add_u32 m0, s14, 51200
    s_add_u32 s11, s14, 49152
    buffer_load_dwordx4 v46, s[48:51], s11 offen lds

    s_add_u32 m0, s14, 52224
    s_add_u32 s11, s14, 52224
    buffer_load_dwordx4 v47, s[48:51], s11 offen lds

    s_add_u32 m0, s14, 53248
    s_add_u32 s11, s14, 52224
    buffer_load_dwordx4 v48, s[48:51], s11 offen lds

    s_add_u32 m0, s14, 54272
    s_add_u32 s11, s14, 52224
    buffer_load_dwordx4 v49, s[48:51], s11 offen lds

    s_barrier
    s_cmp_eq_u32 s3, 3
    s_cselect_b32 s11, 7, 15
    v_and_b32 v20, s11, v3
    v_and_b32 v23, 1, v20
    v_lshrrev_b32 v24, 3, v20
    v_xor_b32 v23, v23, v24
    v_lshlrev_b32 v24, 1, v20
    v_and_b32 v24, 4, v24
    v_or_b32 v23, v23, v24
    v_lshrrev_b32 v24, 1, v20
    v_and_b32 v24, 2, v24
    v_or_b32 v23, v23, v24
    v_xor_b32 v23, v23, v2
    v_lshlrev_b32 v23, 4, v23
    v_mul_u32_u24 v24, 384, v20
    v_add_u32 v23, v23, v24
    v_add_u32 v16, s8, v23
    v_xor_b32 v17, 64, v16
    v_xor_b32 v18, 16, v16
    v_xor_b32 v19, 64, v18
    v_lshrrev_b32 v20, 2, v3
    v_cmp_eq_u32 vcc, v20, v2
    v_and_b32 v21, 3, v3
    v_and_b32 v22, 1, v2
    v_and_b32 v23, 1, v21
    v_mov_b32 v37, 0x3f80
    v_mov_b32 v38, 0x3f800000
    s_mov_b64 s[88:89], vcc
    v_cmp_eq_u32 vcc, 1, v23
    s_nop 1
    v_cndmask_b32 v37, v37, v38, vcc
    v_cndmask_b32 v37, 0, v37, s[88:89]
    v_lshrrev_b32 v21, 1, v21

    v_xor_b32 v23, 0, v22
    v_lshlrev_b32 v23, 1, v23
    v_add_u32 v23, v23, v21
    v_cmp_eq_u32 vcc, 0, v23
    s_nop 1
    v_cndmask_b32 v24, 0, v37, vcc
    v_cmp_eq_u32 vcc, 1, v23
    s_nop 1
    v_cndmask_b32 v25, 0, v37, vcc
    v_cmp_eq_u32 vcc, 2, v23
    s_nop 1
    v_cndmask_b32 v26, 0, v37, vcc
    v_cmp_eq_u32 vcc, 3, v23
    s_nop 1
    v_cndmask_b32 v27, 0, v37, vcc
    v_xor_b32 v23, 1, v22
    v_lshlrev_b32 v23, 1, v23
    v_add_u32 v23, v23, v21
    v_cmp_eq_u32 vcc, 0, v23
    s_nop 1
    v_cndmask_b32 v28, 0, v37, vcc
    v_cmp_eq_u32 vcc, 1, v23
    s_nop 1
    v_cndmask_b32 v29, 0, v37, vcc
    v_cmp_eq_u32 vcc, 2, v23
    s_nop 1
    v_cndmask_b32 v30, 0, v37, vcc
    v_cmp_eq_u32 vcc, 3, v23
    s_nop 1
    v_cndmask_b32 v31, 0, v37, vcc
    v_mov_b32 v32, 0x3f803f80
    v_mov_b32 v33, 0x3f803f80
    v_mov_b32 v34, 0x3f803f80
    v_mov_b32 v35, 0x3f803f80
    v_mov_b32 v36, 1.0
    v_lshrrev_b32 v20, 2, v3
    v_and_b32 v21, 3, v3
    v_lshlrev_b32 v22, 3, v2
    v_add_u32 v22, v22, v20
    v_mul_u32_u24 v22, 384, v22
    v_lshrrev_b32 v23, 1, v20
    v_lshlrev_b32 v23, 2, v23
    v_and_b32 v37, 1, v2
    v_xor_b32 v37, v37, v21
    v_or_b32 v23, v23, v37
    v_lshlrev_b32 v23, 4, v23
    v_and_b32 v37, 1, v21
    v_lshlrev_b32 v37, 3, v37
    v_add3_u32 v40, v22, v23, v37
    v_xor_b32 v41, 8, v40
    v_xor_b32 v42, 64, v40
    v_xor_b32 v43, 72, v40
    v_mov_b32 v38, 159744
    v_mov_b32 v39, 1
    s_mov_b32 s93, 0x3baaaaab

    s_waitcnt vmcnt(18)
    ds_read_b128 v[48:51], v18 offset:64512
    ds_read_b128 v[52:55], v19 offset:64512
    ds_read_b128 v[56:59], v18 offset:64640
    ds_read_b128 v[60:63], v19 offset:64640
    ds_read_b128 v[64:67], v18 offset:64768
    ds_read_b128 v[68:71], v19 offset:64768
    s_lshl_b32 s9, s3, 2
    s_add_u32 s9, s9, 159792
    v_mov_b32 v20, s9
    s_mov_b32 s13, 0
    s_waitcnt lgkmcnt(0)
    s_mov_b64 exec, 1
    ds_write_b32 v20, v39
    s_mov_b64 exec, -1
    s_lshl_b32 s9, s3, 4
    s_add_u32 s9, s9, 159808
    v_mov_b32 v6, s9
    s_mov_b32 s14, 1

    s_waitcnt vmcnt(12)
    v_mov_b32 v21, 159776
    s_mov_b64 exec, 1
    ds_add_u32 v21, v39
    s_mov_b64 exec, -1

L_p_ph0:
    ds_read_b32 v22, v21
    s_waitcnt lgkmcnt(0)
    v_readfirstlane_b32 s9, v22
    s_nop 0
    s_cmp_ge_u32 s9, 4
    s_cbranch_scc1 L_p_ph0_ok
    s_nop 0
    s_add_u32 s13, s13, 1
    s_cmp_lt_u32 s13, 0x100000
    s_cbranch_scc1 L_p_ph0
L_p_ph0_ok:

    ds_read_b64_tr_b16 v[120:121], v40 offset:0
    ds_read_b64_tr_b16 v[122:123], v40 offset:1536
    ds_read_b64_tr_b16 v[124:125], v41 offset:0
    ds_read_b64_tr_b16 v[126:127], v41 offset:1536
    ds_read_b64_tr_b16 v[128:129], v42 offset:0
    ds_read_b64_tr_b16 v[130:131], v42 offset:1536
    ds_read_b64_tr_b16 v[132:133], v43 offset:0
    ds_read_b64_tr_b16 v[134:135], v43 offset:1536
    ds_read_b64_tr_b16 v[136:137], v40 offset:128
    ds_read_b64_tr_b16 v[138:139], v40 offset:1664
    ds_read_b64_tr_b16 v[140:141], v41 offset:128
    ds_read_b64_tr_b16 v[142:143], v41 offset:1664
    ds_read_b64_tr_b16 v[144:145], v42 offset:128
    ds_read_b64_tr_b16 v[146:147], v42 offset:1664
    s_waitcnt lgkmcnt(10)
    v_mfma_f32_16x16x32_bf16 v[72:75], v[120:123], v[48:51], 0
    ds_read_b64_tr_b16 v[120:121], v43 offset:128
    ds_read_b64_tr_b16 v[122:123], v43 offset:1664
    v_mfma_f32_16x16x32_bf16 v[76:79], v[124:127], v[48:51], 0
    ds_read_b64_tr_b16 v[124:125], v40 offset:256
    ds_read_b64_tr_b16 v[126:127], v40 offset:1792
    s_waitcnt lgkmcnt(10)
    v_mfma_f32_16x16x32_bf16 v[80:83], v[128:131], v[48:51], 0
    ds_read_b64_tr_b16 v[128:129], v41 offset:256
    ds_read_b64_tr_b16 v[130:131], v41 offset:1792
    v_mfma_f32_16x16x32_bf16 v[84:87], v[132:135], v[48:51], 0
    ds_read_b64_tr_b16 v[132:133], v42 offset:256
    ds_read_b64_tr_b16 v[134:135], v42 offset:1792
    s_waitcnt lgkmcnt(10)
    v_mfma_f32_16x16x32_bf16 v[88:91], v[136:139], v[48:51], 0
    ds_read_b64_tr_b16 v[136:137], v43 offset:256
    ds_read_b64_tr_b16 v[138:139], v43 offset:1792
    v_mfma_f32_16x16x32_bf16 v[92:95], v[140:143], v[48:51], 0
    ds_read_b64_tr_b16 v[140:141], v40 offset:12288
    ds_read_b64_tr_b16 v[142:143], v40 offset:13824
    s_waitcnt lgkmcnt(10)
    v_mfma_f32_16x16x32_bf16 v[96:99], v[144:147], v[48:51], 0
    ds_read_b64_tr_b16 v[144:145], v41 offset:12288
    ds_read_b64_tr_b16 v[146:147], v41 offset:13824
    v_mfma_f32_16x16x32_bf16 v[100:103], v[120:123], v[48:51], 0
    ds_read_b64_tr_b16 v[120:121], v42 offset:12288
    ds_read_b64_tr_b16 v[122:123], v42 offset:13824
    s_waitcnt lgkmcnt(10)
    v_mfma_f32_16x16x32_bf16 v[104:107], v[124:127], v[48:51], 0
    ds_read_b64_tr_b16 v[124:125], v43 offset:12288
    ds_read_b64_tr_b16 v[126:127], v43 offset:13824
    v_mfma_f32_16x16x32_bf16 v[108:111], v[128:131], v[48:51], 0
    ds_read_b64_tr_b16 v[128:129], v40 offset:12416
    ds_read_b64_tr_b16 v[130:131], v40 offset:13952
    s_waitcnt lgkmcnt(10)
    v_mfma_f32_16x16x32_bf16 v[112:115], v[132:135], v[48:51], 0
    ds_read_b64_tr_b16 v[132:133], v41 offset:12416
    ds_read_b64_tr_b16 v[134:135], v41 offset:13952
    v_mfma_f32_16x16x32_bf16 v[116:119], v[136:139], v[48:51], 0
    ds_read_b64_tr_b16 v[136:137], v42 offset:12416
    ds_read_b64_tr_b16 v[138:139], v42 offset:13952
    s_waitcnt lgkmcnt(10)
    v_mfma_f32_16x16x32_bf16 v[72:75], v[140:143], v[52:55], v[72:75]
    ds_read_b64_tr_b16 v[140:141], v43 offset:12416
    ds_read_b64_tr_b16 v[142:143], v43 offset:13952
    v_mfma_f32_16x16x32_bf16 v[76:79], v[144:147], v[52:55], v[76:79]
    ds_read_b64_tr_b16 v[144:145], v40 offset:12544
    ds_read_b64_tr_b16 v[146:147], v40 offset:14080
    s_waitcnt lgkmcnt(10)
    v_mfma_f32_16x16x32_bf16 v[80:83], v[120:123], v[52:55], v[80:83]
    ds_read_b64_tr_b16 v[120:121], v41 offset:12544
    ds_read_b64_tr_b16 v[122:123], v41 offset:14080
    v_mfma_f32_16x16x32_bf16 v[84:87], v[124:127], v[52:55], v[84:87]
    ds_read_b64_tr_b16 v[124:125], v42 offset:12544
    ds_read_b64_tr_b16 v[126:127], v42 offset:14080
    s_waitcnt lgkmcnt(12)
    v_mfma_f32_16x16x32_bf16 v[88:91], v[128:131], v[52:55], v[88:91]
    ds_read_b64_tr_b16 v[128:129], v43 offset:12544
    ds_read_b64_tr_b16 v[130:131], v43 offset:14080
    s_waitcnt lgkmcnt(12)
    v_mfma_f32_16x16x32_bf16 v[92:95], v[132:135], v[52:55], v[92:95]
    s_waitcnt lgkmcnt(10)
    v_mfma_f32_16x16x32_bf16 v[96:99], v[136:139], v[52:55], v[96:99]
    s_waitcnt lgkmcnt(8)
    v_mfma_f32_16x16x32_bf16 v[100:103], v[140:143], v[52:55], v[100:103]
    s_waitcnt lgkmcnt(6)
    v_mfma_f32_16x16x32_bf16 v[104:107], v[144:147], v[52:55], v[104:107]
    s_waitcnt lgkmcnt(4)
    v_mfma_f32_16x16x32_bf16 v[108:111], v[120:123], v[52:55], v[108:111]
    s_waitcnt lgkmcnt(2)
    v_mfma_f32_16x16x32_bf16 v[112:115], v[124:127], v[52:55], v[112:115]
    s_waitcnt lgkmcnt(0)
    v_mfma_f32_16x16x32_bf16 v[116:119], v[128:131], v[52:55], v[116:119]
    v_mov_b32 v21, 159872
    s_mov_b64 exec, 1
    ds_add_u32 v21, v39
    s_mov_b64 exec, -1
    s_waitcnt vmcnt(6)
    v_mov_b32 v21, 159780
    s_mov_b64 exec, 1
    ds_add_u32 v21, v39
    s_mov_b64 exec, -1

L_p_ph1:
    ds_read_b32 v22, v21
    s_waitcnt lgkmcnt(0)
    v_readfirstlane_b32 s9, v22
    s_nop 0
    s_cmp_ge_u32 s9, 4
    s_cbranch_scc1 L_p_ph1_ok
    s_nop 0
    s_add_u32 s13, s13, 1
    s_cmp_lt_u32 s13, 0x100000
    s_cbranch_scc1 L_p_ph1
L_p_ph1_ok:

    ds_read_b64_tr_b16 v[120:121], v40 offset:24576
    ds_read_b64_tr_b16 v[122:123], v40 offset:26112
    ds_read_b64_tr_b16 v[124:125], v41 offset:24576
    ds_read_b64_tr_b16 v[126:127], v41 offset:26112
    ds_read_b64_tr_b16 v[128:129], v42 offset:24576
    ds_read_b64_tr_b16 v[130:131], v42 offset:26112
    ds_read_b64_tr_b16 v[132:133], v43 offset:24576
    ds_read_b64_tr_b16 v[134:135], v43 offset:26112
    ds_read_b64_tr_b16 v[136:137], v40 offset:24704
    ds_read_b64_tr_b16 v[138:139], v40 offset:26240
    ds_read_b64_tr_b16 v[140:141], v41 offset:24704
    ds_read_b64_tr_b16 v[142:143], v41 offset:26240
    ds_read_b64_tr_b16 v[144:145], v42 offset:24704
    ds_read_b64_tr_b16 v[146:147], v42 offset:26240
    s_waitcnt lgkmcnt(10)
    v_mfma_f32_16x16x32_bf16 v[72:75], v[120:123], v[56:59], v[72:75]
    ds_read_b64_tr_b16 v[120:121], v43 offset:24704
    ds_read_b64_tr_b16 v[122:123], v43 offset:26240
    v_mfma_f32_16x16x32_bf16 v[76:79], v[124:127], v[56:59], v[76:79]
    ds_read_b64_tr_b16 v[124:125], v40 offset:24832
    ds_read_b64_tr_b16 v[126:127], v40 offset:26368
    s_waitcnt lgkmcnt(10)
    v_mfma_f32_16x16x32_bf16 v[80:83], v[128:131], v[56:59], v[80:83]
    ds_read_b64_tr_b16 v[128:129], v41 offset:24832
    ds_read_b64_tr_b16 v[130:131], v41 offset:26368
    v_mfma_f32_16x16x32_bf16 v[84:87], v[132:135], v[56:59], v[84:87]
    ds_read_b64_tr_b16 v[132:133], v42 offset:24832
    ds_read_b64_tr_b16 v[134:135], v42 offset:26368
    s_waitcnt lgkmcnt(10)
    v_mfma_f32_16x16x32_bf16 v[88:91], v[136:139], v[56:59], v[88:91]
    ds_read_b64_tr_b16 v[136:137], v43 offset:24832
    ds_read_b64_tr_b16 v[138:139], v43 offset:26368
    v_mfma_f32_16x16x32_bf16 v[92:95], v[140:143], v[56:59], v[92:95]
    ds_read_b64_tr_b16 v[140:141], v40 offset:36864
    ds_read_b64_tr_b16 v[142:143], v40 offset:38400
    s_waitcnt lgkmcnt(10)
    v_mfma_f32_16x16x32_bf16 v[96:99], v[144:147], v[56:59], v[96:99]
    ds_read_b64_tr_b16 v[144:145], v41 offset:36864
    ds_read_b64_tr_b16 v[146:147], v41 offset:38400
    v_mfma_f32_16x16x32_bf16 v[100:103], v[120:123], v[56:59], v[100:103]
    ds_read_b64_tr_b16 v[120:121], v42 offset:36864
    ds_read_b64_tr_b16 v[122:123], v42 offset:38400
    s_waitcnt lgkmcnt(10)
    v_mfma_f32_16x16x32_bf16 v[104:107], v[124:127], v[56:59], v[104:107]
    ds_read_b64_tr_b16 v[124:125], v43 offset:36864
    ds_read_b64_tr_b16 v[126:127], v43 offset:38400
    v_mfma_f32_16x16x32_bf16 v[108:111], v[128:131], v[56:59], v[108:111]
    ds_read_b64_tr_b16 v[128:129], v40 offset:36992
    ds_read_b64_tr_b16 v[130:131], v40 offset:38528
    s_waitcnt lgkmcnt(10)
    v_mfma_f32_16x16x32_bf16 v[112:115], v[132:135], v[56:59], v[112:115]
    ds_read_b64_tr_b16 v[132:133], v41 offset:36992
    ds_read_b64_tr_b16 v[134:135], v41 offset:38528
    v_mfma_f32_16x16x32_bf16 v[116:119], v[136:139], v[56:59], v[116:119]
    ds_read_b64_tr_b16 v[136:137], v42 offset:36992
    ds_read_b64_tr_b16 v[138:139], v42 offset:38528
    s_waitcnt lgkmcnt(10)
    v_mfma_f32_16x16x32_bf16 v[72:75], v[140:143], v[60:63], v[72:75]
    ds_read_b64_tr_b16 v[140:141], v43 offset:36992
    ds_read_b64_tr_b16 v[142:143], v43 offset:38528
    v_mfma_f32_16x16x32_bf16 v[76:79], v[144:147], v[60:63], v[76:79]
    ds_read_b64_tr_b16 v[144:145], v40 offset:37120
    ds_read_b64_tr_b16 v[146:147], v40 offset:38656
    s_waitcnt lgkmcnt(10)
    v_mfma_f32_16x16x32_bf16 v[80:83], v[120:123], v[60:63], v[80:83]
    ds_read_b64_tr_b16 v[120:121], v41 offset:37120
    ds_read_b64_tr_b16 v[122:123], v41 offset:38656
    v_mfma_f32_16x16x32_bf16 v[84:87], v[124:127], v[60:63], v[84:87]
    ds_read_b64_tr_b16 v[124:125], v42 offset:37120
    ds_read_b64_tr_b16 v[126:127], v42 offset:38656
    s_waitcnt lgkmcnt(12)
    v_mfma_f32_16x16x32_bf16 v[88:91], v[128:131], v[60:63], v[88:91]
    ds_read_b64_tr_b16 v[128:129], v43 offset:37120
    ds_read_b64_tr_b16 v[130:131], v43 offset:38656
    s_waitcnt lgkmcnt(12)
    v_mfma_f32_16x16x32_bf16 v[92:95], v[132:135], v[60:63], v[92:95]
    s_waitcnt lgkmcnt(10)
    v_mfma_f32_16x16x32_bf16 v[96:99], v[136:139], v[60:63], v[96:99]
    s_waitcnt lgkmcnt(8)
    v_mfma_f32_16x16x32_bf16 v[100:103], v[140:143], v[60:63], v[100:103]
    s_waitcnt lgkmcnt(6)
    v_mfma_f32_16x16x32_bf16 v[104:107], v[144:147], v[60:63], v[104:107]
    s_waitcnt lgkmcnt(4)
    v_mfma_f32_16x16x32_bf16 v[108:111], v[120:123], v[60:63], v[108:111]
    s_waitcnt lgkmcnt(2)
    v_mfma_f32_16x16x32_bf16 v[112:115], v[124:127], v[60:63], v[112:115]
    s_waitcnt lgkmcnt(0)
    v_mfma_f32_16x16x32_bf16 v[116:119], v[128:131], v[60:63], v[116:119]
    v_mov_b32 v21, 159880
    s_mov_b64 exec, 1
    ds_add_u32 v21, v39
    s_mov_b64 exec, -1
    s_waitcnt vmcnt(0)
    v_mov_b32 v21, 159784
    s_mov_b64 exec, 1
    ds_add_u32 v21, v39
    s_mov_b64 exec, -1

L_p_ph2:
    ds_read_b32 v22, v21
    s_waitcnt lgkmcnt(0)
    v_readfirstlane_b32 s9, v22
    s_nop 0
    s_cmp_ge_u32 s9, 4
    s_cbranch_scc1 L_p_ph2_ok
    s_nop 0
    s_add_u32 s13, s13, 1
    s_cmp_lt_u32 s13, 0x100000
    s_cbranch_scc1 L_p_ph2
L_p_ph2_ok:

    ds_read_b64_tr_b16 v[120:121], v40 offset:49152
    ds_read_b64_tr_b16 v[122:123], v40 offset:50688
    ds_read_b64_tr_b16 v[124:125], v41 offset:49152
    ds_read_b64_tr_b16 v[126:127], v41 offset:50688
    ds_read_b64_tr_b16 v[128:129], v42 offset:49152
    ds_read_b64_tr_b16 v[130:131], v42 offset:50688
    ds_read_b64_tr_b16 v[132:133], v43 offset:49152
    ds_read_b64_tr_b16 v[134:135], v43 offset:50688
    ds_read_b64_tr_b16 v[136:137], v40 offset:49280
    ds_read_b64_tr_b16 v[138:139], v40 offset:50816
    ds_read_b64_tr_b16 v[140:141], v41 offset:49280
    ds_read_b64_tr_b16 v[142:143], v41 offset:50816
    ds_read_b64_tr_b16 v[144:145], v42 offset:49280
    ds_read_b64_tr_b16 v[146:147], v42 offset:50816
    s_waitcnt lgkmcnt(10)
    v_mfma_f32_16x16x32_bf16 v[72:75], v[120:123], v[64:67], v[72:75]
    ds_read_b64_tr_b16 v[120:121], v43 offset:49280
    ds_read_b64_tr_b16 v[122:123], v43 offset:50816
    v_mfma_f32_16x16x32_bf16 v[76:79], v[124:127], v[64:67], v[76:79]
    ds_read_b64_tr_b16 v[124:125], v40 offset:49408
    ds_read_b64_tr_b16 v[126:127], v40 offset:50944
    s_waitcnt lgkmcnt(10)
    v_mfma_f32_16x16x32_bf16 v[80:83], v[128:131], v[64:67], v[80:83]
    ds_read_b64_tr_b16 v[128:129], v41 offset:49408
    ds_read_b64_tr_b16 v[130:131], v41 offset:50944
    v_mfma_f32_16x16x32_bf16 v[84:87], v[132:135], v[64:67], v[84:87]
    ds_read_b64_tr_b16 v[132:133], v42 offset:49408
    ds_read_b64_tr_b16 v[134:135], v42 offset:50944
    s_waitcnt lgkmcnt(10)
    v_mfma_f32_16x16x32_bf16 v[88:91], v[136:139], v[64:67], v[88:91]
    ds_read_b64_tr_b16 v[136:137], v43 offset:49408
    ds_read_b64_tr_b16 v[138:139], v43 offset:50944
    v_mfma_f32_16x16x32_bf16 v[92:95], v[140:143], v[64:67], v[92:95]
    ds_read_b64_tr_b16 v[140:141], v40 offset:61440
    ds_read_b64_tr_b16 v[142:143], v40 offset:62976
    s_waitcnt lgkmcnt(10)
    v_mfma_f32_16x16x32_bf16 v[96:99], v[144:147], v[64:67], v[96:99]
    ds_read_b64_tr_b16 v[144:145], v41 offset:61440
    ds_read_b64_tr_b16 v[146:147], v41 offset:62976
    v_mfma_f32_16x16x32_bf16 v[100:103], v[120:123], v[64:67], v[100:103]
    ds_read_b64_tr_b16 v[120:121], v42 offset:61440
    ds_read_b64_tr_b16 v[122:123], v42 offset:62976
    s_waitcnt lgkmcnt(10)
    v_mfma_f32_16x16x32_bf16 v[104:107], v[124:127], v[64:67], v[104:107]
    ds_read_b64_tr_b16 v[124:125], v43 offset:61440
    ds_read_b64_tr_b16 v[126:127], v43 offset:62976
    v_mfma_f32_16x16x32_bf16 v[108:111], v[128:131], v[64:67], v[108:111]
    ds_read_b64_tr_b16 v[128:129], v40 offset:61568
    ds_read_b64_tr_b16 v[130:131], v40 offset:63104
    s_waitcnt lgkmcnt(10)
    v_mfma_f32_16x16x32_bf16 v[112:115], v[132:135], v[64:67], v[112:115]
    ds_read_b64_tr_b16 v[132:133], v41 offset:61568
    ds_read_b64_tr_b16 v[134:135], v41 offset:63104
    v_mfma_f32_16x16x32_bf16 v[116:119], v[136:139], v[64:67], v[116:119]
    ds_read_b64_tr_b16 v[136:137], v42 offset:61568
    ds_read_b64_tr_b16 v[138:139], v42 offset:63104
    s_waitcnt lgkmcnt(10)
    v_mfma_f32_16x16x32_bf16 v[72:75], v[140:143], v[68:71], v[72:75]
    ds_read_b64_tr_b16 v[140:141], v43 offset:61568
    ds_read_b64_tr_b16 v[142:143], v43 offset:63104
    v_mfma_f32_16x16x32_bf16 v[76:79], v[144:147], v[68:71], v[76:79]
    ds_read_b64_tr_b16 v[144:145], v40 offset:61696
    ds_read_b64_tr_b16 v[146:147], v40 offset:63232
    s_waitcnt lgkmcnt(10)
    v_mfma_f32_16x16x32_bf16 v[80:83], v[120:123], v[68:71], v[80:83]
    ds_read_b64_tr_b16 v[120:121], v41 offset:61696
    ds_read_b64_tr_b16 v[122:123], v41 offset:63232
    v_mfma_f32_16x16x32_bf16 v[84:87], v[124:127], v[68:71], v[84:87]
    ds_read_b64_tr_b16 v[124:125], v42 offset:61696
    ds_read_b64_tr_b16 v[126:127], v42 offset:63232
    v_mov_b32 v37, v72
    v_add_f32 v37, v37, v73
    v_add_f32 v37, v37, v74
    v_add_f32 v37, v37, v75
    s_waitcnt lgkmcnt(12)
    v_mfma_f32_16x16x32_bf16 v[88:91], v[128:131], v[68:71], v[88:91]
    ds_read_b64_tr_b16 v[128:129], v43 offset:61696
    ds_read_b64_tr_b16 v[130:131], v43 offset:63232
    v_add_f32 v37, v37, v76
    v_add_f32 v37, v37, v77
    v_add_f32 v37, v37, v78
    v_add_f32 v37, v37, v79
    s_waitcnt lgkmcnt(12)
    v_mfma_f32_16x16x32_bf16 v[92:95], v[132:135], v[68:71], v[92:95]
    v_add_f32 v37, v37, v80
    v_add_f32 v37, v37, v81
    v_add_f32 v37, v37, v82
    v_add_f32 v37, v37, v83
    s_waitcnt lgkmcnt(10)
    v_mfma_f32_16x16x32_bf16 v[96:99], v[136:139], v[68:71], v[96:99]
    v_add_f32 v37, v37, v84
    v_add_f32 v37, v37, v85
    v_add_f32 v37, v37, v86
    v_add_f32 v37, v37, v87
    s_waitcnt lgkmcnt(8)
    v_mfma_f32_16x16x32_bf16 v[100:103], v[140:143], v[68:71], v[100:103]
    v_add_f32 v37, v37, v88
    v_add_f32 v37, v37, v89
    v_add_f32 v37, v37, v90
    v_add_f32 v37, v37, v91
    s_waitcnt lgkmcnt(6)
    v_mfma_f32_16x16x32_bf16 v[104:107], v[144:147], v[68:71], v[104:107]
    v_add_f32 v37, v37, v92
    v_add_f32 v37, v37, v93
    v_add_f32 v37, v37, v94
    v_add_f32 v37, v37, v95
    s_waitcnt lgkmcnt(4)
    v_mfma_f32_16x16x32_bf16 v[108:111], v[120:123], v[68:71], v[108:111]
    v_add_f32 v37, v37, v96
    v_add_f32 v37, v37, v97
    v_add_f32 v37, v37, v98
    v_add_f32 v37, v37, v99
    s_waitcnt lgkmcnt(2)
    v_mfma_f32_16x16x32_bf16 v[112:115], v[124:127], v[68:71], v[112:115]
    v_add_f32 v37, v37, v100
    v_add_f32 v37, v37, v101
    v_add_f32 v37, v37, v102
    v_add_f32 v37, v37, v103
    s_waitcnt lgkmcnt(0)
    v_mfma_f32_16x16x32_bf16 v[116:119], v[128:131], v[68:71], v[116:119]
    v_add_f32 v37, v37, v104
    v_add_f32 v37, v37, v105
    v_add_f32 v37, v37, v106
    v_add_f32 v37, v37, v107
    v_add_f32 v37, v37, v108
    v_add_f32 v37, v37, v109
    v_add_f32 v37, v37, v110
    v_add_f32 v37, v37, v111
    v_add_f32 v37, v37, v112
    v_add_f32 v37, v37, v113
    v_add_f32 v37, v37, v114
    v_add_f32 v37, v37, v115
    v_add_f32 v37, v37, v116
    v_add_f32 v37, v37, v117
    v_add_f32 v37, v37, v118
    v_add_f32 v37, v37, v119
    s_nop 1
    v_mfma_f32_16x16x4_f32 v[44:47], v36, v37, 0
    v_mov_b32 v21, 159768
    s_mov_b64 exec, 1
    ds_add_u32 v21, v39
    s_mov_b64 exec, -1
    v_add_u32 v4, 0, v6
L_p_h0:
    ds_read_b32 v5, v4
    s_waitcnt lgkmcnt(0)
    v_readfirstlane_b32 s9, v5
    s_nop 0
    s_cmp_ge_u32 s9, s14
    s_cbranch_scc1 L_p_h0_ok
    s_nop 0
    s_add_u32 s13, s13, 1
    s_cmp_lt_u32 s13, 0x100000
    s_cbranch_scc1 L_p_h0
L_p_h0_ok:

    ds_read_b128 v[48:51], v16 offset:0
    ds_read_b128 v[52:55], v17 offset:0
    ds_read_b128 v[56:59], v16 offset:128
    ds_read_b128 v[60:63], v17 offset:128
    ds_read_b128 v[64:67], v16 offset:256
    ds_read_b128 v[68:71], v17 offset:256
    s_waitcnt lgkmcnt(5)
    v_mfma_f32_16x16x32_bf16 v[120:123], v[24:27], v[48:51], v[72:75]
    v_mfma_f32_16x16x32_bf16 v[124:127], v[28:31], v[48:51], v[76:79]
    s_waitcnt lgkmcnt(4)
    v_mfma_f32_16x16x32_bf16 v[128:131], v[24:27], v[52:55], v[80:83]
    v_mfma_f32_16x16x32_bf16 v[132:135], v[28:31], v[52:55], v[84:87]
    s_waitcnt lgkmcnt(3)
    v_mfma_f32_16x16x32_bf16 v[136:139], v[24:27], v[56:59], v[88:91]
    v_mfma_f32_16x16x32_bf16 v[140:143], v[28:31], v[56:59], v[92:95]
    s_nop 0
    v_mul_f32 v37, v120, v120
    v_fmac_f32 v37, v121, v121
    v_fmac_f32 v37, v122, v122
    s_waitcnt lgkmcnt(2)
    v_mfma_f32_16x16x32_bf16 v[144:147], v[24:27], v[60:63], v[96:99]
    v_fmac_f32 v37, v123, v123
    v_fmac_f32 v37, v124, v124
    v_fmac_f32 v37, v125, v125
    v_mfma_f32_16x16x32_bf16 v[148:151], v[28:31], v[60:63], v[100:103]
    v_fmac_f32 v37, v126, v126
    v_fmac_f32 v37, v127, v127
    v_fmac_f32 v37, v128, v128
    s_waitcnt lgkmcnt(1)
    v_mfma_f32_16x16x32_bf16 v[152:155], v[24:27], v[64:67], v[104:107]
    v_fmac_f32 v37, v129, v129
    v_fmac_f32 v37, v130, v130
    v_fmac_f32 v37, v131, v131
    v_mfma_f32_16x16x32_bf16 v[156:159], v[28:31], v[64:67], v[108:111]
    v_fmac_f32 v37, v132, v132
    v_fmac_f32 v37, v133, v133
    v_fmac_f32 v37, v134, v134
    s_waitcnt lgkmcnt(0)
    v_mfma_f32_16x16x32_bf16 v[160:163], v[24:27], v[68:71], v[112:115]
    v_fmac_f32 v37, v135, v135
    v_fmac_f32 v37, v136, v136
    v_fmac_f32 v37, v137, v137
    v_mfma_f32_16x16x32_bf16 v[164:167], v[28:31], v[68:71], v[116:119]
    v_fmac_f32 v37, v138, v138
    v_fmac_f32 v37, v139, v139
    v_fmac_f32 v37, v140, v140
    v_mfma_f32_16x16x32_bf16 v[240:243], v[32:35], v[48:51], v[44:47]
    v_fmac_f32 v37, v141, v141
    v_fmac_f32 v37, v142, v142
    v_fmac_f32 v37, v143, v143
    v_mfma_f32_16x16x32_bf16 v[240:243], v[32:35], v[52:55], v[240:243]
    v_fmac_f32 v37, v144, v144
    v_fmac_f32 v37, v145, v145
    v_fmac_f32 v37, v146, v146
    v_mfma_f32_16x16x32_bf16 v[240:243], v[32:35], v[56:59], v[240:243]
    v_fmac_f32 v37, v147, v147
    v_fmac_f32 v37, v148, v148
    v_fmac_f32 v37, v149, v149
    v_mfma_f32_16x16x32_bf16 v[240:243], v[32:35], v[60:63], v[240:243]
    v_fmac_f32 v37, v150, v150
    v_fmac_f32 v37, v151, v151
    v_fmac_f32 v37, v152, v152
    v_mfma_f32_16x16x32_bf16 v[240:243], v[32:35], v[64:67], v[240:243]
    v_fmac_f32 v37, v153, v153
    v_fmac_f32 v37, v154, v154
    v_fmac_f32 v37, v155, v155
    v_mfma_f32_16x16x32_bf16 v[240:243], v[32:35], v[68:71], v[240:243]
    v_fmac_f32 v37, v156, v156
    v_fmac_f32 v37, v157, v157
    v_fmac_f32 v37, v158, v158
    v_fmac_f32 v37, v159, v159
    v_fmac_f32 v37, v160, v160
    v_fmac_f32 v37, v161, v161
    v_fmac_f32 v37, v162, v162
    v_fmac_f32 v37, v163, v163
    v_fmac_f32 v37, v164, v164
    v_fmac_f32 v37, v165, v165
    v_fmac_f32 v37, v166, v166
    v_fmac_f32 v37, v167, v167
    v_add_u32 v4, 4, v6
L_p_h1:
    ds_read_b32 v5, v4
    s_waitcnt lgkmcnt(0)
    v_readfirstlane_b32 s9, v5
    s_nop 0
    s_cmp_ge_u32 s9, s14
    s_cbranch_scc1 L_p_h1_ok
    s_nop 0
    s_add_u32 s13, s13, 1
    s_cmp_lt_u32 s13, 0x100000
    s_cbranch_scc1 L_p_h1
L_p_h1_ok:

    ds_read_b128 v[48:51], v18 offset:21504
    ds_read_b128 v[52:55], v19 offset:21504
    ds_read_b128 v[56:59], v18 offset:21632
    ds_read_b128 v[60:63], v19 offset:21632
    ds_read_b128 v[64:67], v18 offset:21760
    ds_read_b128 v[68:71], v19 offset:21760
    v_mfma_f32_16x16x4_f32 v[248:251], v36, v37, 0
    s_waitcnt lgkmcnt(4)
    v_mfma_f32_16x16x32_bf16 v[168:171], v[24:27], v[48:51], v[72:75]
    v_mfma_f32_16x16x32_bf16 v[172:175], v[28:31], v[48:51], v[76:79]
    v_mfma_f32_16x16x32_bf16 v[176:179], v[24:27], v[52:55], v[80:83]
    v_mfma_f32_16x16x32_bf16 v[180:183], v[28:31], v[52:55], v[84:87]
    v_mul_f32 v252, s93, v240
    v_mul_f32 v21, v252, v252
    s_nop 2
    v_fma_f32 v21, v248, s93, -v21
    v_add_f32 v21, 0x3727c5ac, v21
    v_rsq_f32 v21, v21
    s_nop 0
    v_mul_f32 v22, v252, v21
    v_sub_f32 v22, 0, v22
    s_waitcnt lgkmcnt(0)
    v_mfma_f32_16x16x32_bf16 v[184:187], v[24:27], v[56:59], v[88:91]
    v_fma_f32 v120, v120, v21, v22
    v_fma_f32 v121, v121, v21, v22
    v_fma_f32 v122, v122, v21, v22
    v_fma_f32 v123, v123, v21, v22
    v_fma_f32 v124, v124, v21, v22
    v_mfma_f32_16x16x32_bf16 v[188:191], v[28:31], v[56:59], v[92:95]
    v_fma_f32 v125, v125, v21, v22
    v_fma_f32 v126, v126, v21, v22
    v_fma_f32 v127, v127, v21, v22
    v_cvt_pk_bf16_f32 v216, v120, v121
    v_cvt_pk_bf16_f32 v217, v122, v123
    v_mfma_f32_16x16x32_bf16 v[192:195], v[24:27], v[60:63], v[96:99]
    v_cvt_pk_bf16_f32 v218, v124, v125
    v_cvt_pk_bf16_f32 v219, v126, v127
    ds_write_b128 v16, v[216:219] offset:0
    v_fma_f32 v128, v128, v21, v22
    v_fma_f32 v129, v129, v21, v22
    v_mfma_f32_16x16x32_bf16 v[196:199], v[28:31], v[60:63], v[100:103]
    v_fma_f32 v130, v130, v21, v22
    v_fma_f32 v131, v131, v21, v22
    v_fma_f32 v132, v132, v21, v22
    v_fma_f32 v133, v133, v21, v22
    v_fma_f32 v134, v134, v21, v22
    v_mfma_f32_16x16x32_bf16 v[200:203], v[24:27], v[64:67], v[104:107]
    v_fma_f32 v135, v135, v21, v22
    v_cvt_pk_bf16_f32 v220, v128, v129
    v_cvt_pk_bf16_f32 v221, v130, v131
    v_cvt_pk_bf16_f32 v222, v132, v133
    v_cvt_pk_bf16_f32 v223, v134, v135
    v_mfma_f32_16x16x32_bf16 v[204:207], v[28:31], v[64:67], v[108:111]
    ds_write_b128 v17, v[220:223] offset:0
    v_fma_f32 v136, v136, v21, v22
    v_fma_f32 v137, v137, v21, v22
    v_fma_f32 v138, v138, v21, v22
    v_fma_f32 v139, v139, v21, v22
    v_mfma_f32_16x16x32_bf16 v[208:211], v[24:27], v[68:71], v[112:115]
    v_fma_f32 v140, v140, v21, v22
    v_fma_f32 v141, v141, v21, v22
    v_fma_f32 v142, v142, v21, v22
    v_fma_f32 v143, v143, v21, v22
    v_cvt_pk_bf16_f32 v224, v136, v137
    v_mfma_f32_16x16x32_bf16 v[212:215], v[28:31], v[68:71], v[116:119]
    v_cvt_pk_bf16_f32 v225, v138, v139
    v_cvt_pk_bf16_f32 v226, v140, v141
    v_cvt_pk_bf16_f32 v227, v142, v143
    ds_write_b128 v16, v[224:227] offset:128
    v_fma_f32 v144, v144, v21, v22
    v_mfma_f32_16x16x32_bf16 v[244:247], v[32:35], v[48:51], v[44:47]
    v_fma_f32 v145, v145, v21, v22
    v_fma_f32 v146, v146, v21, v22
    v_fma_f32 v147, v147, v21, v22
    v_fma_f32 v148, v148, v21, v22
    v_fma_f32 v149, v149, v21, v22
    v_mfma_f32_16x16x32_bf16 v[244:247], v[32:35], v[52:55], v[244:247]
    v_fma_f32 v150, v150, v21, v22
    v_fma_f32 v151, v151, v21, v22
    v_cvt_pk_bf16_f32 v228, v144, v145
    v_cvt_pk_bf16_f32 v229, v146, v147
    v_cvt_pk_bf16_f32 v230, v148, v149
    v_mfma_f32_16x16x32_bf16 v[244:247], v[32:35], v[56:59], v[244:247]
    v_cvt_pk_bf16_f32 v231, v150, v151
    ds_write_b128 v17, v[228:231] offset:128
    v_fma_f32 v152, v152, v21, v22
    v_fma_f32 v153, v153, v21, v22
    v_fma_f32 v154, v154, v21, v22
    v_mfma_f32_16x16x32_bf16 v[244:247], v[32:35], v[60:63], v[244:247]
    v_fma_f32 v155, v155, v21, v22
    v_fma_f32 v156, v156, v21, v22
    v_fma_f32 v157, v157, v21, v22
    v_fma_f32 v158, v158, v21, v22
    v_fma_f32 v159, v159, v21, v22
    v_mfma_f32_16x16x32_bf16 v[244:247], v[32:35], v[64:67], v[244:247]
    v_cvt_pk_bf16_f32 v232, v152, v153
    v_cvt_pk_bf16_f32 v233, v154, v155
    v_cvt_pk_bf16_f32 v234, v156, v157
    v_cvt_pk_bf16_f32 v235, v158, v159
    ds_write_b128 v16, v[232:235] offset:256
    v_mfma_f32_16x16x32_bf16 v[244:247], v[32:35], v[68:71], v[244:247]
    v_fma_f32 v160, v160, v21, v22
    v_fma_f32 v161, v161, v21, v22
    v_fma_f32 v162, v162, v21, v22
    v_fma_f32 v163, v163, v21, v22
    v_fma_f32 v164, v164, v21, v22
    v_fma_f32 v165, v165, v21, v22
    v_fma_f32 v166, v166, v21, v22
    v_fma_f32 v167, v167, v21, v22
    v_cvt_pk_bf16_f32 v236, v160, v161
    v_cvt_pk_bf16_f32 v237, v162, v163
    v_cvt_pk_bf16_f32 v238, v164, v165
    v_cvt_pk_bf16_f32 v239, v166, v167
    ds_write_b128 v17, v[236:239] offset:256
    s_mov_b64 exec, 1
    ds_add_u32 v38, v39 offset:0
    s_mov_b64 exec, -1
    v_mul_f32 v37, v168, v168
    v_fmac_f32 v37, v169, v169
    v_fmac_f32 v37, v170, v170
    v_fmac_f32 v37, v171, v171
    v_fmac_f32 v37, v172, v172
    v_fmac_f32 v37, v173, v173
    v_fmac_f32 v37, v174, v174
    v_fmac_f32 v37, v175, v175
    v_fmac_f32 v37, v176, v176
    v_fmac_f32 v37, v177, v177
    v_fmac_f32 v37, v178, v178
    v_fmac_f32 v37, v179, v179
    v_fmac_f32 v37, v180, v180
    v_fmac_f32 v37, v181, v181
    v_fmac_f32 v37, v182, v182
    v_fmac_f32 v37, v183, v183
    v_fmac_f32 v37, v184, v184
    v_fmac_f32 v37, v185, v185
    v_fmac_f32 v37, v186, v186
    v_fmac_f32 v37, v187, v187
    v_fmac_f32 v37, v188, v188
    v_fmac_f32 v37, v189, v189
    v_fmac_f32 v37, v190, v190
    v_fmac_f32 v37, v191, v191
    v_fmac_f32 v37, v192, v192
    v_fmac_f32 v37, v193, v193
    v_fmac_f32 v37, v194, v194
    v_fmac_f32 v37, v195, v195
    v_fmac_f32 v37, v196, v196
    v_fmac_f32 v37, v197, v197
    v_fmac_f32 v37, v198, v198
    v_fmac_f32 v37, v199, v199
    v_fmac_f32 v37, v200, v200
    v_fmac_f32 v37, v201, v201
    v_fmac_f32 v37, v202, v202
    v_fmac_f32 v37, v203, v203
    v_fmac_f32 v37, v204, v204
    v_fmac_f32 v37, v205, v205
    v_fmac_f32 v37, v206, v206
    v_fmac_f32 v37, v207, v207
    v_fmac_f32 v37, v208, v208
    v_fmac_f32 v37, v209, v209
    v_fmac_f32 v37, v210, v210
    v_fmac_f32 v37, v211, v211
    v_fmac_f32 v37, v212, v212
    v_fmac_f32 v37, v213, v213
    v_fmac_f32 v37, v214, v214
    v_fmac_f32 v37, v215, v215
    v_add_u32 v4, 8, v6
L_p_h2:
    ds_read_b32 v5, v4
    s_waitcnt lgkmcnt(0)
    v_readfirstlane_b32 s9, v5
    s_nop 0
    s_cmp_ge_u32 s9, s14
    s_cbranch_scc1 L_p_h2_ok
    s_nop 0
    s_add_u32 s13, s13, 1
    s_cmp_lt_u32 s13, 0x100000
    s_cbranch_scc1 L_p_h2
L_p_h2_ok:

    ds_read_b128 v[48:51], v16 offset:43008
    ds_read_b128 v[52:55], v17 offset:43008
    ds_read_b128 v[56:59], v16 offset:43136
    ds_read_b128 v[60:63], v17 offset:43136
    ds_read_b128 v[64:67], v16 offset:43264
    ds_read_b128 v[68:71], v17 offset:43264
    v_mfma_f32_16x16x4_f32 v[248:251], v36, v37, 0
    s_waitcnt lgkmcnt(4)
    v_mfma_f32_16x16x32_bf16 v[120:123], v[24:27], v[48:51], v[72:75]
    v_mfma_f32_16x16x32_bf16 v[124:127], v[28:31], v[48:51], v[76:79]
    v_mfma_f32_16x16x32_bf16 v[128:131], v[24:27], v[52:55], v[80:83]
    v_mfma_f32_16x16x32_bf16 v[132:135], v[28:31], v[52:55], v[84:87]
    v_mul_f32 v252, s93, v244
    v_mul_f32 v21, v252, v252
    s_nop 2
    v_fma_f32 v21, v248, s93, -v21
    v_add_f32 v21, 0x3727c5ac, v21
    v_rsq_f32 v21, v21
    s_nop 0
    v_mul_f32 v22, v252, v21
    v_sub_f32 v22, 0, v22
    s_waitcnt lgkmcnt(0)
    v_mfma_f32_16x16x32_bf16 v[136:139], v[24:27], v[56:59], v[88:91]
    v_fma_f32 v168, v168, v21, v22
    v_fma_f32 v169, v169, v21, v22
    v_fma_f32 v170, v170, v21, v22
    v_fma_f32 v171, v171, v21, v22
    v_fma_f32 v172, v172, v21, v22
    v_mfma_f32_16x16x32_bf16 v[140:143], v[28:31], v[56:59], v[92:95]
    v_fma_f32 v173, v173, v21, v22
    v_fma_f32 v174, v174, v21, v22
    v_fma_f32 v175, v175, v21, v22
    v_cvt_pk_bf16_f32 v216, v168, v169
    v_cvt_pk_bf16_f32 v217, v170, v171
    v_mfma_f32_16x16x32_bf16 v[144:147], v[24:27], v[60:63], v[96:99]
    v_cvt_pk_bf16_f32 v218, v172, v173
    v_cvt_pk_bf16_f32 v219, v174, v175
    ds_write_b128 v18, v[216:219] offset:21504
    v_fma_f32 v176, v176, v21, v22
    v_fma_f32 v177, v177, v21, v22
    v_mfma_f32_16x16x32_bf16 v[148:151], v[28:31], v[60:63], v[100:103]
    v_fma_f32 v178, v178, v21, v22
    v_fma_f32 v179, v179, v21, v22
    v_fma_f32 v180, v180, v21, v22
    v_fma_f32 v181, v181, v21, v22
    v_fma_f32 v182, v182, v21, v22
    v_mfma_f32_16x16x32_bf16 v[152:155], v[24:27], v[64:67], v[104:107]
    v_fma_f32 v183, v183, v21, v22
    v_cvt_pk_bf16_f32 v220, v176, v177
    v_cvt_pk_bf16_f32 v221, v178, v179
    v_cvt_pk_bf16_f32 v222, v180, v181
    v_cvt_pk_bf16_f32 v223, v182, v183
    v_mfma_f32_16x16x32_bf16 v[156:159], v[28:31], v[64:67], v[108:111]
    ds_write_b128 v19, v[220:223] offset:21504
    v_fma_f32 v184, v184, v21, v22
    v_fma_f32 v185, v185, v21, v22
    v_fma_f32 v186, v186, v21, v22
    v_fma_f32 v187, v187, v21, v22
    v_mfma_f32_16x16x32_bf16 v[160:163], v[24:27], v[68:71], v[112:115]
    v_fma_f32 v188, v188, v21, v22
    v_fma_f32 v189, v189, v21, v22
    v_fma_f32 v190, v190, v21, v22
    v_fma_f32 v191, v191, v21, v22
    v_cvt_pk_bf16_f32 v224, v184, v185
    v_mfma_f32_16x16x32_bf16 v[164:167], v[28:31], v[68:71], v[116:119]
    v_cvt_pk_bf16_f32 v225, v186, v187
    v_cvt_pk_bf16_f32 v226, v188, v189
    v_cvt_pk_bf16_f32 v227, v190, v191
    ds_write_b128 v18, v[224:227] offset:21632
    v_fma_f32 v192, v192, v21, v22
    v_mfma_f32_16x16x32_bf16 v[240:243], v[32:35], v[48:51], v[44:47]
    v_fma_f32 v193, v193, v21, v22
    v_fma_f32 v194, v194, v21, v22
    v_fma_f32 v195, v195, v21, v22
    v_fma_f32 v196, v196, v21, v22
    v_fma_f32 v197, v197, v21, v22
    v_mfma_f32_16x16x32_bf16 v[240:243], v[32:35], v[52:55], v[240:243]
    v_fma_f32 v198, v198, v21, v22
    v_fma_f32 v199, v199, v21, v22
    v_cvt_pk_bf16_f32 v228, v192, v193
    v_cvt_pk_bf16_f32 v229, v194, v195
    v_cvt_pk_bf16_f32 v230, v196, v197
    v_mfma_f32_16x16x32_bf16 v[240:243], v[32:35], v[56:59], v[240:243]
    v_cvt_pk_bf16_f32 v231, v198, v199
    ds_write_b128 v19, v[228:231] offset:21632
    v_fma_f32 v200, v200, v21, v22
    v_fma_f32 v201, v201, v21, v22
    v_fma_f32 v202, v202, v21, v22
    v_mfma_f32_16x16x32_bf16 v[240:243], v[32:35], v[60:63], v[240:243]
    v_fma_f32 v203, v203, v21, v22
    v_fma_f32 v204, v204, v21, v22
    v_fma_f32 v205, v205, v21, v22
    v_fma_f32 v206, v206, v21, v22
    v_fma_f32 v207, v207, v21, v22
    v_mfma_f32_16x16x32_bf16 v[240:243], v[32:35], v[64:67], v[240:243]
    v_cvt_pk_bf16_f32 v232, v200, v201
    v_cvt_pk_bf16_f32 v233, v202, v203
    v_cvt_pk_bf16_f32 v234, v204, v205
    v_cvt_pk_bf16_f32 v235, v206, v207
    ds_write_b128 v18, v[232:235] offset:21760
    v_mfma_f32_16x16x32_bf16 v[240:243], v[32:35], v[68:71], v[240:243]
    v_fma_f32 v208, v208, v21, v22
    v_fma_f32 v209, v209, v21, v22
    v_fma_f32 v210, v210, v21, v22
    v_fma_f32 v211, v211, v21, v22
    v_fma_f32 v212, v212, v21, v22
    v_fma_f32 v213, v213, v21, v22
    v_fma_f32 v214, v214, v21, v22
    v_fma_f32 v215, v215, v21, v22
    v_cvt_pk_bf16_f32 v236, v208, v209
    v_cvt_pk_bf16_f32 v237, v210, v211
    v_cvt_pk_bf16_f32 v238, v212, v213
    v_cvt_pk_bf16_f32 v239, v214, v215
    ds_write_b128 v19, v[236:239] offset:21760
    s_mov_b64 exec, 1
    ds_add_u32 v38, v39 offset:4
    s_mov_b64 exec, -1
    v_mul_f32 v37, v120, v120
    v_fmac_f32 v37, v121, v121
    v_fmac_f32 v37, v122, v122
    v_fmac_f32 v37, v123, v123
    v_fmac_f32 v37, v124, v124
    v_fmac_f32 v37, v125, v125
    v_fmac_f32 v37, v126, v126
    v_fmac_f32 v37, v127, v127
    v_fmac_f32 v37, v128, v128
    v_fmac_f32 v37, v129, v129
    v_fmac_f32 v37, v130, v130
    v_fmac_f32 v37, v131, v131
    v_fmac_f32 v37, v132, v132
    v_fmac_f32 v37, v133, v133
    v_fmac_f32 v37, v134, v134
    v_fmac_f32 v37, v135, v135
    v_fmac_f32 v37, v136, v136
    v_fmac_f32 v37, v137, v137
    v_fmac_f32 v37, v138, v138
    v_fmac_f32 v37, v139, v139
    v_fmac_f32 v37, v140, v140
    v_fmac_f32 v37, v141, v141
    v_fmac_f32 v37, v142, v142
    v_fmac_f32 v37, v143, v143
    v_fmac_f32 v37, v144, v144
    v_fmac_f32 v37, v145, v145
    v_fmac_f32 v37, v146, v146
    v_fmac_f32 v37, v147, v147
    v_fmac_f32 v37, v148, v148
    v_fmac_f32 v37, v149, v149
    v_fmac_f32 v37, v150, v150
    v_fmac_f32 v37, v151, v151
    v_fmac_f32 v37, v152, v152
    v_fmac_f32 v37, v153, v153
    v_fmac_f32 v37, v154, v154
    v_fmac_f32 v37, v155, v155
    v_fmac_f32 v37, v156, v156
    v_fmac_f32 v37, v157, v157
    v_fmac_f32 v37, v158, v158
    v_fmac_f32 v37, v159, v159
    v_fmac_f32 v37, v160, v160
    v_fmac_f32 v37, v161, v161
    v_fmac_f32 v37, v162, v162
    v_fmac_f32 v37, v163, v163
    v_fmac_f32 v37, v164, v164
    v_fmac_f32 v37, v165, v165
    v_fmac_f32 v37, v166, v166
    v_fmac_f32 v37, v167, v167
    v_add_u32 v4, 12, v6
L_p_h3:
    ds_read_b32 v5, v4
    s_waitcnt lgkmcnt(0)
    v_readfirstlane_b32 s9, v5
    s_nop 0
    s_cmp_ge_u32 s9, s14
    s_cbranch_scc1 L_p_h3_ok
    s_nop 0
    s_add_u32 s13, s13, 1
    s_cmp_lt_u32 s13, 0x100000
    s_cbranch_scc1 L_p_h3
L_p_h3_ok:

    ds_read_b128 v[48:51], v18 offset:64512
    ds_read_b128 v[52:55], v19 offset:64512
    ds_read_b128 v[56:59], v18 offset:64640
    ds_read_b128 v[60:63], v19 offset:64640
    ds_read_b128 v[64:67], v18 offset:64768
    ds_read_b128 v[68:71], v19 offset:64768
    v_mfma_f32_16x16x4_f32 v[248:251], v36, v37, 0
    s_waitcnt lgkmcnt(4)
    v_mfma_f32_16x16x32_bf16 v[168:171], v[24:27], v[48:51], v[72:75]
    v_mfma_f32_16x16x32_bf16 v[172:175], v[28:31], v[48:51], v[76:79]
    v_mfma_f32_16x16x32_bf16 v[176:179], v[24:27], v[52:55], v[80:83]
    v_mfma_f32_16x16x32_bf16 v[180:183], v[28:31], v[52:55], v[84:87]
    v_mul_f32 v252, s93, v240
    v_mul_f32 v21, v252, v252
    s_nop 2
    v_fma_f32 v21, v248, s93, -v21
    v_add_f32 v21, 0x3727c5ac, v21
    v_rsq_f32 v21, v21
    s_nop 0
    v_mul_f32 v22, v252, v21
    v_sub_f32 v22, 0, v22
    s_waitcnt lgkmcnt(0)
    v_mfma_f32_16x16x32_bf16 v[184:187], v[24:27], v[56:59], v[88:91]
    v_fma_f32 v120, v120, v21, v22
    v_fma_f32 v121, v121, v21, v22
    v_fma_f32 v122, v122, v21, v22
    v_fma_f32 v123, v123, v21, v22
    v_fma_f32 v124, v124, v21, v22
    v_mfma_f32_16x16x32_bf16 v[188:191], v[28:31], v[56:59], v[92:95]
    v_fma_f32 v125, v125, v21, v22
    v_fma_f32 v126, v126, v21, v22
    v_fma_f32 v127, v127, v21, v22
    v_cvt_pk_bf16_f32 v216, v120, v121
    v_cvt_pk_bf16_f32 v217, v122, v123
    v_mfma_f32_16x16x32_bf16 v[192:195], v[24:27], v[60:63], v[96:99]
    v_cvt_pk_bf16_f32 v218, v124, v125
    v_cvt_pk_bf16_f32 v219, v126, v127
    ds_write_b128 v16, v[216:219] offset:43008
    v_fma_f32 v128, v128, v21, v22
    v_fma_f32 v129, v129, v21, v22
    v_mfma_f32_16x16x32_bf16 v[196:199], v[28:31], v[60:63], v[100:103]
    v_fma_f32 v130, v130, v21, v22
    v_fma_f32 v131, v131, v21, v22
    v_fma_f32 v132, v132, v21, v22
    v_fma_f32 v133, v133, v21, v22
    v_fma_f32 v134, v134, v21, v22
    v_mfma_f32_16x16x32_bf16 v[200:203], v[24:27], v[64:67], v[104:107]
    v_fma_f32 v135, v135, v21, v22
    v_cvt_pk_bf16_f32 v220, v128, v129
    v_cvt_pk_bf16_f32 v221, v130, v131
    v_cvt_pk_bf16_f32 v222, v132, v133
    v_cvt_pk_bf16_f32 v223, v134, v135
    v_mfma_f32_16x16x32_bf16 v[204:207], v[28:31], v[64:67], v[108:111]
    ds_write_b128 v17, v[220:223] offset:43008
    v_fma_f32 v136, v136, v21, v22
    v_fma_f32 v137, v137, v21, v22
    v_fma_f32 v138, v138, v21, v22
    v_fma_f32 v139, v139, v21, v22
    v_mfma_f32_16x16x32_bf16 v[208:211], v[24:27], v[68:71], v[112:115]
    v_fma_f32 v140, v140, v21, v22
    v_fma_f32 v141, v141, v21, v22
    v_fma_f32 v142, v142, v21, v22
    v_fma_f32 v143, v143, v21, v22
    v_cvt_pk_bf16_f32 v224, v136, v137
    v_mfma_f32_16x16x32_bf16 v[212:215], v[28:31], v[68:71], v[116:119]
    v_cvt_pk_bf16_f32 v225, v138, v139
    v_cvt_pk_bf16_f32 v226, v140, v141
    v_cvt_pk_bf16_f32 v227, v142, v143
    ds_write_b128 v16, v[224:227] offset:43136
    v_fma_f32 v144, v144, v21, v22
    v_mfma_f32_16x16x32_bf16 v[244:247], v[32:35], v[48:51], v[44:47]
    v_fma_f32 v145, v145, v21, v22
    v_fma_f32 v146, v146, v21, v22
    v_fma_f32 v147, v147, v21, v22
    v_fma_f32 v148, v148, v21, v22
    v_fma_f32 v149, v149, v21, v22
    v_mfma_f32_16x16x32_bf16 v[244:247], v[32:35], v[52:55], v[244:247]
    v_fma_f32 v150, v150, v21, v22
    v_fma_f32 v151, v151, v21, v22
    v_cvt_pk_bf16_f32 v228, v144, v145
    v_cvt_pk_bf16_f32 v229, v146, v147
    v_cvt_pk_bf16_f32 v230, v148, v149
    v_mfma_f32_16x16x32_bf16 v[244:247], v[32:35], v[56:59], v[244:247]
    v_cvt_pk_bf16_f32 v231, v150, v151
    ds_write_b128 v17, v[228:231] offset:43136
    v_fma_f32 v152, v152, v21, v22
    v_fma_f32 v153, v153, v21, v22
    v_fma_f32 v154, v154, v21, v22
    v_mfma_f32_16x16x32_bf16 v[244:247], v[32:35], v[60:63], v[244:247]
    v_fma_f32 v155, v155, v21, v22
    v_fma_f32 v156, v156, v21, v22
    v_fma_f32 v157, v157, v21, v22
    v_fma_f32 v158, v158, v21, v22
    v_fma_f32 v159, v159, v21, v22
    v_mfma_f32_16x16x32_bf16 v[244:247], v[32:35], v[64:67], v[244:247]
    v_cvt_pk_bf16_f32 v232, v152, v153
    v_cvt_pk_bf16_f32 v233, v154, v155
    v_cvt_pk_bf16_f32 v234, v156, v157
    v_cvt_pk_bf16_f32 v235, v158, v159
    ds_write_b128 v16, v[232:235] offset:43264
    v_mfma_f32_16x16x32_bf16 v[244:247], v[32:35], v[68:71], v[244:247]
    v_fma_f32 v160, v160, v21, v22
    v_fma_f32 v161, v161, v21, v22
    v_fma_f32 v162, v162, v21, v22
    v_fma_f32 v163, v163, v21, v22
    v_fma_f32 v164, v164, v21, v22
    v_fma_f32 v165, v165, v21, v22
    v_fma_f32 v166, v166, v21, v22
    v_fma_f32 v167, v167, v21, v22
    v_cvt_pk_bf16_f32 v236, v160, v161
    v_cvt_pk_bf16_f32 v237, v162, v163
    v_cvt_pk_bf16_f32 v238, v164, v165
    v_cvt_pk_bf16_f32 v239, v166, v167
    ds_write_b128 v17, v[236:239] offset:43264
    s_mov_b64 exec, 1
    ds_add_u32 v38, v39 offset:8
    s_mov_b64 exec, -1
    v_mul_f32 v37, v168, v168
    v_fmac_f32 v37, v169, v169
    v_fmac_f32 v37, v170, v170
    v_fmac_f32 v37, v171, v171
    v_fmac_f32 v37, v172, v172
    v_fmac_f32 v37, v173, v173
    v_fmac_f32 v37, v174, v174
    v_fmac_f32 v37, v175, v175
    v_fmac_f32 v37, v176, v176
    v_fmac_f32 v37, v177, v177
    v_fmac_f32 v37, v178, v178
    v_fmac_f32 v37, v179, v179
    v_fmac_f32 v37, v180, v180
    v_fmac_f32 v37, v181, v181
    v_fmac_f32 v37, v182, v182
    v_fmac_f32 v37, v183, v183
    v_fmac_f32 v37, v184, v184
    v_fmac_f32 v37, v185, v185
    v_fmac_f32 v37, v186, v186
    v_fmac_f32 v37, v187, v187
    v_fmac_f32 v37, v188, v188
    v_fmac_f32 v37, v189, v189
    v_fmac_f32 v37, v190, v190
    v_fmac_f32 v37, v191, v191
    v_fmac_f32 v37, v192, v192
    v_fmac_f32 v37, v193, v193
    v_fmac_f32 v37, v194, v194
    v_fmac_f32 v37, v195, v195
    v_fmac_f32 v37, v196, v196
    v_fmac_f32 v37, v197, v197
    v_fmac_f32 v37, v198, v198
    v_fmac_f32 v37, v199, v199
    v_fmac_f32 v37, v200, v200
    v_fmac_f32 v37, v201, v201
    v_fmac_f32 v37, v202, v202
    v_fmac_f32 v37, v203, v203
    v_fmac_f32 v37, v204, v204
    v_fmac_f32 v37, v205, v205
    v_fmac_f32 v37, v206, v206
    v_fmac_f32 v37, v207, v207
    v_fmac_f32 v37, v208, v208
    v_fmac_f32 v37, v209, v209
    v_fmac_f32 v37, v210, v210
    v_fmac_f32 v37, v211, v211
    v_fmac_f32 v37, v212, v212
    v_fmac_f32 v37, v213, v213
    v_fmac_f32 v37, v214, v214
    v_fmac_f32 v37, v215, v215
    s_nop 1
    v_mfma_f32_16x16x4_f32 v[248:251], v36, v37, 0
    v_mul_f32 v252, s93, v244
    v_mul_f32 v21, v252, v252
    s_nop 7
    v_fma_f32 v21, v248, s93, -v21
    v_add_f32 v21, 0x3727c5ac, v21
    v_rsq_f32 v21, v21
    s_nop 0
    v_mul_f32 v22, v252, v21
    v_sub_f32 v22, 0, v22
    v_fma_f32 v168, v168, v21, v22
    v_fma_f32 v169, v169, v21, v22
    v_fma_f32 v170, v170, v21, v22
    v_fma_f32 v171, v171, v21, v22
    v_fma_f32 v172, v172, v21, v22
    v_fma_f32 v173, v173, v21, v22
    v_fma_f32 v174, v174, v21, v22
    v_fma_f32 v175, v175, v21, v22
    v_cvt_pk_bf16_f32 v216, v168, v169
    v_cvt_pk_bf16_f32 v217, v170, v171
    v_cvt_pk_bf16_f32 v218, v172, v173
    v_cvt_pk_bf16_f32 v219, v174, v175
    ds_write_b128 v18, v[216:219] offset:64512
    v_fma_f32 v176, v176, v21, v22
    v_fma_f32 v177, v177, v21, v22
    v_fma_f32 v178, v178, v21, v22
    v_fma_f32 v179, v179, v21, v22
    v_fma_f32 v180, v180, v21, v22
    v_fma_f32 v181, v181, v21, v22
    v_fma_f32 v182, v182, v21, v22
    v_fma_f32 v183, v183, v21, v22
    v_cvt_pk_bf16_f32 v220, v176, v177
    v_cvt_pk_bf16_f32 v221, v178, v179
    v_cvt_pk_bf16_f32 v222, v180, v181
    v_cvt_pk_bf16_f32 v223, v182, v183
    ds_write_b128 v19, v[220:223] offset:64512
    v_fma_f32 v184, v184, v21, v22
    v_fma_f32 v185, v185, v21, v22
    v_fma_f32 v186, v186, v21, v22
    v_fma_f32 v187, v187, v21, v22
    v_fma_f32 v188, v188, v21, v22
    v_fma_f32 v189, v189, v21, v22
    v_fma_f32 v190, v190, v21, v22
    v_fma_f32 v191, v191, v21, v22
    v_cvt_pk_bf16_f32 v224, v184, v185
    v_cvt_pk_bf16_f32 v225, v186, v187
    v_cvt_pk_bf16_f32 v226, v188, v189
    v_cvt_pk_bf16_f32 v227, v190, v191
    ds_write_b128 v18, v[224:227] offset:64640
    v_fma_f32 v192, v192, v21, v22
    v_fma_f32 v193, v193, v21, v22
    v_fma_f32 v194, v194, v21, v22
    v_fma_f32 v195, v195, v21, v22
    v_fma_f32 v196, v196, v21, v22
    v_fma_f32 v197, v197, v21, v22
    v_fma_f32 v198, v198, v21, v22
    v_fma_f32 v199, v199, v21, v22
    v_cvt_pk_bf16_f32 v228, v192, v193
    v_cvt_pk_bf16_f32 v229, v194, v195
    v_cvt_pk_bf16_f32 v230, v196, v197
    v_cvt_pk_bf16_f32 v231, v198, v199
    ds_write_b128 v19, v[228:231] offset:64640
    v_fma_f32 v200, v200, v21, v22
    v_fma_f32 v201, v201, v21, v22
    v_fma_f32 v202, v202, v21, v22
    v_fma_f32 v203, v203, v21, v22
    v_fma_f32 v204, v204, v21, v22
    v_fma_f32 v205, v205, v21, v22
    v_fma_f32 v206, v206, v21, v22
    v_fma_f32 v207, v207, v21, v22
    v_cvt_pk_bf16_f32 v232, v200, v201
    v_cvt_pk_bf16_f32 v233, v202, v203
    v_cvt_pk_bf16_f32 v234, v204, v205
    v_cvt_pk_bf16_f32 v235, v206, v207
    ds_write_b128 v18, v[232:235] offset:64768
    v_fma_f32 v208, v208, v21, v22
    v_fma_f32 v209, v209, v21, v22
    v_fma_f32 v210, v210, v21, v22
    v_fma_f32 v211, v211, v21, v22
    v_fma_f32 v212, v212, v21, v22
    v_fma_f32 v213, v213, v21, v22
    v_fma_f32 v214, v214, v21, v22
    v_fma_f32 v215, v215, v21, v22
    v_cvt_pk_bf16_f32 v236, v208, v209
    v_cvt_pk_bf16_f32 v237, v210, v211
    v_cvt_pk_bf16_f32 v238, v212, v213
    v_cvt_pk_bf16_f32 v239, v214, v215
    ds_write_b128 v19, v[236:239] offset:64768
    s_mov_b64 exec, 1
    ds_add_u32 v38, v39 offset:12
    s_mov_b64 exec, -1
    s_mov_b32 s52, s28
    s_mov_b32 s53, s29
    s_mov_b32 s54, 73728
    s_mov_b32 s55, 0x00020000
    v_mov_b32 v21, 159772
    v_lshlrev_b32 v20, 4, v1
    s_mul_i32 s7, s3, 8192
    s_mov_b32 s13, 0
L_p_wr:
    ds_read_b32 v22, v21
    s_waitcnt lgkmcnt(0)
    v_readfirstlane_b32 s9, v22
    s_nop 0
    s_cmp_ge_u32 s9, 4
    s_cbranch_scc1 L_p_wr_ok
    s_sleep 1
    s_add_u32 s13, s13, 1
    s_cmp_lt_u32 s13, 0x100000
    s_cbranch_scc1 L_p_wr
L_p_wr_ok:

    s_add_u32 m0, s7, 0
    s_add_u32 s9, s7, 0
    buffer_load_dwordx4 v20, s[52:55], s9 offen lds
    s_add_u32 m0, s7, 1024
    s_add_u32 s9, s7, 1024
    buffer_load_dwordx4 v20, s[52:55], s9 offen lds
    s_add_u32 m0, s7, 2048
    s_add_u32 s9, s7, 2048
    buffer_load_dwordx4 v20, s[52:55], s9 offen lds
    s_add_u32 m0, s7, 3072
    s_add_u32 s9, s7, 3072
    buffer_load_dwordx4 v20, s[52:55], s9 offen lds
    s_add_u32 m0, s7, 4096
    s_add_u32 s9, s7, 4096
    buffer_load_dwordx4 v20, s[52:55], s9 offen lds
    s_add_u32 m0, s7, 5120
    s_add_u32 s9, s7, 5120
    buffer_load_dwordx4 v20, s[52:55], s9 offen lds
    s_add_u32 m0, s7, 6144
    s_add_u32 s9, s7, 6144
    buffer_load_dwordx4 v20, s[52:55], s9 offen lds
    s_add_u32 m0, s7, 7168
    s_add_u32 s9, s7, 7168
    buffer_load_dwordx4 v20, s[52:55], s9 offen lds
    v_mov_b32 v21, 159764
    s_waitcnt vmcnt(0)
    s_mov_b64 exec, 1
    ds_add_u32 v21, v39
    s_mov_b64 exec, -1

    s_barrier
    s_barrier
    s_branch L_end
L_consumer:
    v_and_b32 v1, 63, v0
    s_sub_u32 s4, s3, 4
    s_and_b32 s5, s4, 1
    s_lshr_b32 s6, s4, 1

    s_cmp_lg_u32 s4, 0
    s_cbranch_scc1 L_c_nopf
    s_cmp_ge_u32 s15, 16
    s_cbranch_scc1 L_c_nopf
    v_lshlrev_b32 v16, 7, v1

    v_add_u32 v17, 0, v16
    v_min_u32 v17, 31616, v17
    global_load_dword v18, v17, s[94:95]
    v_add_u32 v17, 8192, v16
    v_min_u32 v17, 31616, v17
    global_load_dword v18, v17, s[94:95]
    v_add_u32 v17, 16384, v16
    v_min_u32 v17, 31616, v17
    global_load_dword v18, v17, s[94:95]
    v_add_u32 v17, 24576, v16
    v_min_u32 v17, 31616, v17
    global_load_dword v18, v17, s[94:95]
L_c_nopf:
    s_cmp_lg_u32 s4, 0
    s_cbranch_scc1 L_c_noinit0
    v_lshlrev_b32 v20, 2, v1
    v_add_u32 v20, 159744, v20
    v_mov_b32 v21, 0
    ds_write_b32 v20, v21
L_c_noinit0:

    v_add_u32 v20, 0, v1
    v_mul_u32_u24 v21, 2731, v20
    v_lshrrev_b32 v21, 16, v21
    v_mul_u32_u24 v23, 24, v21
    v_sub_u32 v22, v20, v23

    v_lshlrev_b32 v24, 1, v21
    v_and_b32 v24, 4, v24
    v_and_b32 v23, 1, v21
    v_or_b32 v23, v23, v24
    v_lshrrev_b32 v24, 1, v21
    v_and_b32 v24, 2, v24
    v_or_b32 v23, v23, v24
    v_xor_b32 v22, v22, v23
    v_lshlrev_b32 v22, 4, v22
    v_mul_u32_u24 v26, 768, v21
    v_add_u32 v32, v26, v22
    v_xor_b32 v35, 16, v32

    v_add_u32 v20, 64, v1
    v_mul_u32_u24 v21, 2731, v20
    v_lshrrev_b32 v21, 16, v21
    v_mul_u32_u24 v23, 24, v21
    v_sub_u32 v22, v20, v23

    v_lshlrev_b32 v24, 1, v21
    v_and_b32 v24, 4, v24
    v_and_b32 v23, 1, v21
    v_or_b32 v23, v23, v24
    v_lshrrev_b32 v24, 1, v21
    v_and_b32 v24, 2, v24
    v_or_b32 v23, v23, v24
    v_xor_b32 v22, v22, v23
    v_lshlrev_b32 v22, 4, v22
    v_mul_u32_u24 v26, 768, v21
    v_add_u32 v33, v26, v22
    v_xor_b32 v36, 16, v33

    v_add_u32 v20, 128, v1
    v_mul_u32_u24 v21, 2731, v20
    v_lshrrev_b32 v21, 16, v21
    v_mul_u32_u24 v23, 24, v21
    v_sub_u32 v22, v20, v23

    v_lshlrev_b32 v24, 1, v21
    v_and_b32 v24, 4, v24
    v_and_b32 v23, 1, v21
    v_or_b32 v23, v23, v24
    v_lshrrev_b32 v24, 1, v21
    v_and_b32 v24, 2, v24
    v_or_b32 v23, v23, v24
    v_xor_b32 v22, v22, v23
    v_lshlrev_b32 v22, 4, v22
    v_mul_u32_u24 v26, 768, v21
    v_add_u32 v34, v26, v22
    v_xor_b32 v37, 16, v34

    s_lshr_b32 s7, s15, 1
    s_and_b32 s8, s15, 1
    s_mul_i32 s60, s7, 172032
    s_mul_i32 s8, s8, 43008
    s_add_u32 s60, s60, s8
    s_max_u32 s8, s4, 2
    s_sub_u32 s8, s8, 2
    s_mul_i32 s9, s8, 24576
    s_add_u32 s60, s60, s9
    s_mul_i32 s61, s8, 12288
    s_add_u32 s61, s61, 73728
    s_waitcnt lgkmcnt(0)

    s_mov_b32 s40, s18
    s_mov_b32 s41, s19
    s_mov_b32 s42, 19267584
    s_mov_b32 s43, 0x00020000
    s_barrier
    s_cmp_lt_u32 s4, 2
    s_cbranch_scc1 L_c_noload
    s_cmp_eq_u32 s4, 3
    s_cbranch_scc1 L_c_load7
    s_add_u32 m0, s61, 0
    s_add_u32 s11, s60, 0
    buffer_load_dwordx4 v32, s[40:43], s11 offen nt lds
    s_add_u32 m0, s61, 1024
    s_add_u32 s11, s60, 0
    buffer_load_dwordx4 v33, s[40:43], s11 offen nt lds
    s_add_u32 m0, s61, 2048
    s_add_u32 s11, s60, 0
    buffer_load_dwordx4 v34, s[40:43], s11 offen nt lds
    s_add_u32 m0, s61, 3072
    s_add_u32 s11, s60, 6144
    buffer_load_dwordx4 v35, s[40:43], s11 offen nt lds
    s_add_u32 m0, s61, 4096
    s_add_u32 s11, s60, 6144
    buffer_load_dwordx4 v36, s[40:43], s11 offen nt lds
    s_add_u32 m0, s61, 5120
    s_add_u32 s11, s60, 6144
    buffer_load_dwordx4 v37, s[40:43], s11 offen nt lds
    s_add_u32 m0, s61, 6144
    s_add_u32 s11, s60, 12288
    buffer_load_dwordx4 v32, s[40:43], s11 offen nt lds
    s_add_u32 m0, s61, 7168
    s_add_u32 s11, s60, 12288
    buffer_load_dwordx4 v33, s[40:43], s11 offen nt lds
    s_add_u32 m0, s61, 8192
    s_add_u32 s11, s60, 12288
    buffer_load_dwordx4 v34, s[40:43], s11 offen nt lds
    s_add_u32 m0, s61, 9216
    s_add_u32 s11, s60, 18432
    buffer_load_dwordx4 v35, s[40:43], s11 offen nt lds
    s_add_u32 m0, s61, 10240
    s_add_u32 s11, s60, 18432
    buffer_load_dwordx4 v36, s[40:43], s11 offen nt lds
    s_add_u32 m0, s61, 11264
    s_add_u32 s11, s60, 18432
    buffer_load_dwordx4 v37, s[40:43], s11 offen nt lds
    s_add_u32 m0, s61, 21504
    s_add_u32 s11, s60, 384
    buffer_load_dwordx4 v35, s[40:43], s11 offen nt lds
    s_add_u32 m0, s61, 22528
    s_add_u32 s11, s60, 384
    buffer_load_dwordx4 v36, s[40:43], s11 offen nt lds
    s_add_u32 m0, s61, 23552
    s_add_u32 s11, s60, 384
    buffer_load_dwordx4 v37, s[40:43], s11 offen nt lds
    s_add_u32 m0, s61, 24576
    s_add_u32 s11, s60, 6528
    buffer_load_dwordx4 v32, s[40:43], s11 offen nt lds
    s_add_u32 m0, s61, 25600
    s_add_u32 s11, s60, 6528
    buffer_load_dwordx4 v33, s[40:43], s11 offen nt lds
    s_add_u32 m0, s61, 26624
    s_add_u32 s11, s60, 6528
    buffer_load_dwordx4 v34, s[40:43], s11 offen nt lds
    s_add_u32 m0, s61, 27648
    s_add_u32 s11, s60, 12672
    buffer_load_dwordx4 v35, s[40:43], s11 offen nt lds
    s_add_u32 m0, s61, 28672
    s_add_u32 s11, s60, 12672
    buffer_load_dwordx4 v36, s[40:43], s11 offen nt lds
    s_add_u32 m0, s61, 29696
    s_add_u32 s11, s60, 12672
    buffer_load_dwordx4 v37, s[40:43], s11 offen nt lds
    s_add_u32 m0, s61, 30720
    s_add_u32 s11, s60, 18816
    buffer_load_dwordx4 v32, s[40:43], s11 offen nt lds
    s_add_u32 m0, s61, 31744
    s_add_u32 s11, s60, 18816
    buffer_load_dwordx4 v33, s[40:43], s11 offen nt lds
    s_add_u32 m0, s61, 32768
    s_add_u32 s11, s60, 18816
    buffer_load_dwordx4 v34, s[40:43], s11 offen nt lds
    s_branch L_c_noload
L_c_load7:
    s_add_u32 m0, s61, 0
    s_add_u32 s11, s60, 0
    buffer_load_dwordx4 v32, s[40:43], s11 offen nt lds
    s_add_u32 m0, s61, 1024
    s_add_u32 s11, s60, 0
    buffer_load_dwordx4 v33, s[40:43], s11 offen nt lds
    s_add_u32 m0, s61, 2048
    s_add_u32 s11, s60, 0
    buffer_load_dwordx4 v34, s[40:43], s11 offen nt lds
    s_add_u32 m0, s61, 3072
    s_add_u32 s11, s60, 6144
    buffer_load_dwordx4 v35, s[40:43], s11 offen nt lds
    s_add_u32 m0, s61, 4096
    s_add_u32 s11, s60, 6144
    buffer_load_dwordx4 v36, s[40:43], s11 offen nt lds
    s_add_u32 m0, s61, 5120
    s_add_u32 s11, s60, 6144
    buffer_load_dwordx4 v37, s[40:43], s11 offen nt lds
    s_add_u32 m0, s61, 6144
    s_add_u32 s11, s60, 12288
    buffer_load_dwordx4 v32, s[40:43], s11 offen nt lds
    s_add_u32 m0, s61, 7168
    s_add_u32 s11, s60, 12288
    buffer_load_dwordx4 v33, s[40:43], s11 offen nt lds
    s_add_u32 m0, s61, 8192
    s_add_u32 s11, s60, 12288
    buffer_load_dwordx4 v34, s[40:43], s11 offen nt lds
    s_add_u32 m0, s61, 21504
    s_add_u32 s11, s60, 384
    buffer_load_dwordx4 v35, s[40:43], s11 offen nt lds
    s_add_u32 m0, s61, 22528
    s_add_u32 s11, s60, 384
    buffer_load_dwordx4 v36, s[40:43], s11 offen nt lds
    s_add_u32 m0, s61, 23552
    s_add_u32 s11, s60, 384
    buffer_load_dwordx4 v37, s[40:43], s11 offen nt lds
    s_add_u32 m0, s61, 24576
    s_add_u32 s11, s60, 6528
    buffer_load_dwordx4 v32, s[40:43], s11 offen nt lds
    s_add_u32 m0, s61, 25600
    s_add_u32 s11, s60, 6528
    buffer_load_dwordx4 v33, s[40:43], s11 offen nt lds
    s_add_u32 m0, s61, 26624
    s_add_u32 s11, s60, 6528
    buffer_load_dwordx4 v34, s[40:43], s11 offen nt lds
    s_add_u32 m0, s61, 27648
    s_add_u32 s11, s60, 12672
    buffer_load_dwordx4 v35, s[40:43], s11 offen nt lds
    s_add_u32 m0, s61, 28672
    s_add_u32 s11, s60, 12672
    buffer_load_dwordx4 v36, s[40:43], s11 offen nt lds
    s_add_u32 m0, s61, 29696
    s_add_u32 s11, s60, 12672
    buffer_load_dwordx4 v37, s[40:43], s11 offen nt lds
L_c_noload:
    s_load_dword s91, s[38:39], 0xc000
    s_mov_b32 s56, s38
    s_mov_b32 s57, s39
    s_mov_b32 s58, 268435456
    s_mov_b32 s59, 0x00020000
    s_mov_b32 s52, s28
    s_mov_b32 s53, s29
    s_mov_b32 s54, 73728
    s_mov_b32 s55, 0x00020000
    v_lshrrev_b32 v2, 5, v1
    v_and_b32 v3, 31, v1
    v_and_b32 v20, 1, v3
    v_lshrrev_b32 v21, 3, v3
    v_and_b32 v21, 1, v21
    v_xor_b32 v20, v20, v21
    v_lshlrev_b32 v21, 1, v3
    v_and_b32 v21, 4, v21
    v_or_b32 v20, v20, v21
    v_lshrrev_b32 v21, 1, v3
    v_and_b32 v21, 2, v21
    v_or_b32 v20, v20, v21
    v_xor_b32 v20, v20, v2
    v_lshlrev_b32 v20, 4, v20
    v_mul_u32_u24 v21, 384, v3
    v_add_u32 v20, v20, v21
    s_mul_i32 s8, s6, 12288
    s_add_u32 s8, s8, 73728
    v_add_u32 v8, s8, v20
    v_xor_b32 v9, 32, v8
    v_xor_b32 v10, 64, v8
    v_xor_b32 v11, 96, v8
    v_lshrrev_b32 v20, 4, v1
    v_and_b32 v20, 1, v20
    v_lshrrev_b32 v21, 2, v1
    v_and_b32 v21, 3, v21
    v_and_b32 v22, 3, v1
    v_lshlrev_b32 v23, 2, v2
    v_add_u32 v23, v23, v21
    v_mul_u32_u24 v23, 384, v23
    v_and_b32 v24, 1, v21
    v_lshlrev_b32 v25, 1, v21
    v_and_b32 v25, 4, v25
    v_or_b32 v24, v24, v25
    v_lshlrev_b32 v25, 1, v2
    v_or_b32 v24, v24, v25
    v_lshlrev_b32 v25, 1, v20
    v_lshrrev_b32 v26, 1, v22
    v_add_u32 v25, v25, v26
    v_xor_b32 v25, v25, v24
    v_lshlrev_b32 v25, 4, v25
    v_and_b32 v26, 1, v22
    v_lshlrev_b32 v26, 3, v26
    v_add3_u32 v23, v23, v25, v26
    v_add_u32 v12, s8, v23
    v_xor_b32 v13, 16, v12
    v_xor_b32 v14, 64, v12
    v_xor_b32 v15, 80, v12

    v_mov_b32 v80, 0
    v_mov_b32 v81, 0
    v_mov_b32 v82, 0
    v_mov_b32 v83, 0
    v_mov_b32 v84, 0
    v_mov_b32 v85, 0
    v_mov_b32 v86, 0
    v_mov_b32 v87, 0
    v_mov_b32 v88, 0
    v_mov_b32 v89, 0
    v_mov_b32 v90, 0
    v_mov_b32 v91, 0
    v_mov_b32 v92, 0
    v_mov_b32 v93, 0
    v_mov_b32 v94, 0
    v_mov_b32 v95, 0
    v_mov_b32 v96, 0
    v_mov_b32 v97, 0
    v_mov_b32 v98, 0
    v_mov_b32 v99, 0
    v_mov_b32 v100, 0
    v_mov_b32 v101, 0
    v_mov_b32 v102, 0
    v_mov_b32 v103, 0
    v_mov_b32 v104, 0
    v_mov_b32 v105, 0
    v_mov_b32 v106, 0
    v_mov_b32 v107, 0
    v_mov_b32 v108, 0
    v_mov_b32 v109, 0
    v_mov_b32 v110, 0
    v_mov_b32 v111, 0
    v_mov_b32 v112, 0
    v_mov_b32 v113, 0
    v_mov_b32 v114, 0
    v_mov_b32 v115, 0
    v_mov_b32 v116, 0
    v_mov_b32 v117, 0
    v_mov_b32 v118, 0
    v_mov_b32 v119, 0
    v_mov_b32 v120, 0
    v_mov_b32 v121, 0
    v_mov_b32 v122, 0
    v_mov_b32 v123, 0
    v_mov_b32 v124, 0
    v_mov_b32 v125, 0
    v_mov_b32 v126, 0
    v_mov_b32 v127, 0
    v_mov_b32 v128, 0
    v_mov_b32 v129, 0
    v_mov_b32 v130, 0
    v_mov_b32 v131, 0
    v_mov_b32 v132, 0
    v_mov_b32 v133, 0
    v_mov_b32 v134, 0
    v_mov_b32 v135, 0
    v_mov_b32 v136, 0
    v_mov_b32 v137, 0
    v_mov_b32 v138, 0
    v_mov_b32 v139, 0
    v_mov_b32 v140, 0
    v_mov_b32 v141, 0
    v_mov_b32 v142, 0
    v_mov_b32 v143, 0
    v_mov_b32 v144, 0
    v_mov_b32 v145, 0
    v_mov_b32 v146, 0
    v_mov_b32 v147, 0
    v_mov_b32 v148, 0
    v_mov_b32 v149, 0
    v_mov_b32 v150, 0
    v_mov_b32 v151, 0
    v_mov_b32 v152, 0
    v_mov_b32 v153, 0
    v_mov_b32 v154, 0
    v_mov_b32 v155, 0
    v_mov_b32 v156, 0
    v_mov_b32 v157, 0
    v_mov_b32 v158, 0
    v_mov_b32 v159, 0
    v_mov_b32 v160, 0
    v_mov_b32 v161, 0
    v_mov_b32 v162, 0
    v_mov_b32 v163, 0
    v_mov_b32 v164, 0
    v_mov_b32 v165, 0
    v_mov_b32 v166, 0
    v_mov_b32 v167, 0
    v_mov_b32 v168, 0
    v_mov_b32 v169, 0
    v_mov_b32 v170, 0
    v_mov_b32 v171, 0
    v_mov_b32 v172, 0
    v_mov_b32 v173, 0
    v_mov_b32 v174, 0
    v_mov_b32 v175, 0
    v_mov_b32 v16, 0
    v_mov_b32 v17, 0
    v_lshrrev_b32 v20, 4, v1
    v_and_b32 v22, 1, v20
    v_lshrrev_b32 v23, 1, v20
    v_mul_u32_u24 v22, 12, v22
    v_lshlrev_b32 v24, 2, v23
    v_xor_b32 v22, v22, v24
    v_lshrrev_b32 v23, 2, v1
    v_and_b32 v23, 3, v23
    v_add_u32 v22, v22, v23
    v_mul_u32_u24 v22, 96, v22
    v_and_b32 v23, 3, v1
    v_mul_u32_u24 v23, 24, v23
    v_add_u32 v22, v22, v23
    s_mul_i32 s9, s5, 36864
    v_add_u32 v2, s9, v22
    v_add_u32 v3, 18432, v2
    v_and_b32 v20, 15, v1
    v_mul_u32_u24 v21, 208, v20
    v_lshrrev_b32 v22, 4, v1
    v_mul_u32_u24 v22, 48, v22
    v_add_u32 v21, v21, v22
    s_lshl_b32 s9, s4, 13
    s_add_u32 s9, s9, 73728
    v_add_u32 v4, s9, v21
    v_lshlrev_b32 v22, 3, v20
    v_add_u32 v5, s9, v22
    v_lshrrev_b32 v23, 3, v1
    v_and_b32 v24, 3, v1
    v_lshlrev_b32 v24, 1, v24
    v_lshrrev_b32 v25, 2, v1
    v_and_b32 v25, 1, v25
    v_or_b32 v24, v24, v25
    v_mul_u32_u24 v25, 208, v23
    v_mul_u32_u24 v26, 24, v24
    v_add_u32 v25, v25, v26
    s_lshl_b32 s8, s6, 12
    s_and_b32 s9, s4, 1
    s_lshl_b32 s9, s9, 13
    s_add_u32 s9, s9, s8
    s_add_u32 s9, s9, 73728
    v_add_u32 v6, s9, v25
    v_lshlrev_b32 v26, 3, v23
    v_add_u32 v7, s9, v26
    s_mov_b32 s9, 114688
    v_mul_lo_u32 v23, v23, s9
    v_and_b32 v25, 1, v24
    v_mul_u32_u24 v25, 14336, v25
    v_lshrrev_b32 v24, 1, v24
    v_lshlrev_b32 v24, 4, v24
    v_add3_u32 v23, v23, v24, v25
    s_lshl_b32 s9, s5, 1
    s_add_u32 s9, s9, s6
    s_mul_i32 s9, s9, 28672
    s_and_b32 s8, s15, 7
    s_mul_i32 s8, s8, 28
    s_lshr_b32 s24, s15, 3
    s_add_u32 s8, s8, s24
    s_lshl_b32 s8, s8, 6
    s_add_u32 s24, s9, s8
    s_add_u32 s24, s24, 65536
    s_add_u32 s25, s24, 917504
    v_and_b32 v24, 4, v1
    v_cmp_eq_u32 s[26:27], 4, v24

    s_waitcnt lgkmcnt(0)
    s_add_u32 s90, s91, 1
    s_and_b32 s89, s90, 0xffff
    s_mov_b32 s13, 0
    s_cmp_lt_u32 s4, 2
    s_cbranch_scc1 L_c_waitA
    s_sub_u32 s9, s4, 2
    s_lshl_b32 s9, s9, 5
    s_add_u32 s9, s9, 159808
    v_mov_b32 v28, s9
    v_mov_b32 v29, 1
    s_cmp_eq_u32 s4, 3
    s_cbranch_scc1 L_c_w7
    v_mov_b32 v21, 159876

    s_waitcnt vmcnt(12)
    s_mov_b64 exec, 1
    ds_add_u32 v28, v29 offset:0
    ds_add_u32 v28, v29 offset:16
    s_mov_b64 exec, -1

L_c_wy:
    ds_read_b32 v22, v21
    s_waitcnt lgkmcnt(0)
    v_readfirstlane_b32 s9, v22
    s_nop 0
    s_cmp_ge_u32 s9, 1
    s_cbranch_scc1 L_c_wy_ok
    s_sleep 1
    s_add_u32 s13, s13, 1
    s_cmp_lt_u32 s13, 0x100000
    s_cbranch_scc1 L_c_wy
L_c_wy_ok:

    s_add_u32 m0, s61, 43008
    s_add_u32 s11, s60, 86016
    buffer_load_dwordx4 v32, s[40:43], s11 offen nt lds
    s_add_u32 m0, s61, 44032
    s_add_u32 s11, s60, 86016
    buffer_load_dwordx4 v33, s[40:43], s11 offen nt lds
    s_add_u32 m0, s61, 45056
    s_add_u32 s11, s60, 86016
    buffer_load_dwordx4 v34, s[40:43], s11 offen nt lds
    s_add_u32 m0, s61, 46080
    s_add_u32 s11, s60, 92160
    buffer_load_dwordx4 v35, s[40:43], s11 offen nt lds
    s_add_u32 m0, s61, 47104
    s_add_u32 s11, s60, 92160
    buffer_load_dwordx4 v36, s[40:43], s11 offen nt lds
    s_add_u32 m0, s61, 48128
    s_add_u32 s11, s60, 92160
    buffer_load_dwordx4 v37, s[40:43], s11 offen nt lds
    s_add_u32 m0, s61, 49152
    s_add_u32 s11, s60, 98304
    buffer_load_dwordx4 v32, s[40:43], s11 offen nt lds
    s_add_u32 m0, s61, 50176
    s_add_u32 s11, s60, 98304
    buffer_load_dwordx4 v33, s[40:43], s11 offen nt lds
    s_add_u32 m0, s61, 51200
    s_add_u32 s11, s60, 98304
    buffer_load_dwordx4 v34, s[40:43], s11 offen nt lds
    s_add_u32 m0, s61, 52224
    s_add_u32 s11, s60, 104448
    buffer_load_dwordx4 v35, s[40:43], s11 offen nt lds
    s_add_u32 m0, s61, 53248
    s_add_u32 s11, s60, 104448
    buffer_load_dwordx4 v36, s[40:43], s11 offen nt lds
    s_add_u32 m0, s61, 54272
    s_add_u32 s11, s60, 104448
    buffer_load_dwordx4 v37, s[40:43], s11 offen nt lds
    s_waitcnt vmcnt(12)
    s_mov_b64 exec, 1
    ds_add_u32 v28, v29 offset:4
    ds_add_u32 v28, v29 offset:20
    s_mov_b64 exec, -1

    v_mov_b32 v21, 159792
L_c6_wf0:
    ds_read_b32 v22, v21
    s_waitcnt lgkmcnt(0)
    v_readfirstlane_b32 s9, v22
    s_nop 0
    s_cmp_ge_u32 s9, 1
    s_cbranch_scc1 L_c6_wf0_ok
    s_sleep 1
    s_add_u32 s13, s13, 1
    s_cmp_lt_u32 s13, 0x100000
    s_cbranch_scc1 L_c6_wf0
L_c6_wf0_ok:

    v_mov_b32 v21, 159796
L_c6_wf1:
    ds_read_b32 v22, v21
    s_waitcnt lgkmcnt(0)
    v_readfirstlane_b32 s9, v22
    s_nop 0
    s_cmp_ge_u32 s9, 1
    s_cbranch_scc1 L_c6_wf1_ok
    s_sleep 1
    s_add_u32 s13, s13, 1
    s_cmp_lt_u32 s13, 0x100000
    s_cbranch_scc1 L_c6_wf1
L_c6_wf1_ok:

    v_mov_b32 v21, 159800
L_c6_wf2:
    ds_read_b32 v22, v21
    s_waitcnt lgkmcnt(0)
    v_readfirstlane_b32 s9, v22
    s_nop 0
    s_cmp_ge_u32 s9, 1
    s_cbranch_scc1 L_c6_wf2_ok
    s_sleep 1
    s_add_u32 s13, s13, 1
    s_cmp_lt_u32 s13, 0x100000
    s_cbranch_scc1 L_c6_wf2
L_c6_wf2_ok:

    v_mov_b32 v21, 159804
L_c6_wf3:
    ds_read_b32 v22, v21
    s_waitcnt lgkmcnt(0)
    v_readfirstlane_b32 s9, v22
    s_nop 0
    s_cmp_ge_u32 s9, 1
    s_cbranch_scc1 L_c6_wf3_ok
    s_sleep 1
    s_add_u32 s13, s13, 1
    s_cmp_lt_u32 s13, 0x100000
    s_cbranch_scc1 L_c6_wf3
L_c6_wf3_ok:

    s_add_u32 m0, s61, 64512
    s_add_u32 s11, s60, 86400
    buffer_load_dwordx4 v35, s[40:43], s11 offen nt lds
    s_add_u32 m0, s61, 65536
    s_add_u32 s11, s60, 86400
    buffer_load_dwordx4 v36, s[40:43], s11 offen nt lds
    s_add_u32 m0, s61, 66560
    s_add_u32 s11, s60, 86400
    buffer_load_dwordx4 v37, s[40:43], s11 offen nt lds
    s_add_u32 m0, s61, 67584
    s_add_u32 s11, s60, 92544
    buffer_load_dwordx4 v32, s[40:43], s11 offen nt lds
    s_add_u32 m0, s61, 68608
    s_add_u32 s11, s60, 92544
    buffer_load_dwordx4 v33, s[40:43], s11 offen nt lds
    s_add_u32 m0, s61, 69632
    s_add_u32 s11, s60, 92544
    buffer_load_dwordx4 v34, s[40:43], s11 offen nt lds
    s_add_u32 m0, s61, 70656
    s_add_u32 s11, s60, 98688
    buffer_load_dwordx4 v35, s[40:43], s11 offen nt lds
    s_add_u32 m0, s61, 71680
    s_add_u32 s11, s60, 98688
    buffer_load_dwordx4 v36, s[40:43], s11 offen nt lds
    s_add_u32 m0, s61, 72704
    s_add_u32 s11, s60, 98688
    buffer_load_dwordx4 v37, s[40:43], s11 offen nt lds
    s_add_u32 m0, s61, 73728
    s_add_u32 s11, s60, 104832
    buffer_load_dwordx4 v32, s[40:43], s11 offen nt lds
    s_add_u32 m0, s61, 74752
    s_add_u32 s11, s60, 104832
    buffer_load_dwordx4 v33, s[40:43], s11 offen nt lds
    s_add_u32 m0, s61, 75776
    s_add_u32 s11, s60, 104832
    buffer_load_dwordx4 v34, s[40:43], s11 offen nt lds
    s_waitcnt vmcnt(12)
    s_mov_b64 exec, 1
    ds_add_u32 v28, v29 offset:8
    ds_add_u32 v28, v29 offset:24
    s_mov_b64 exec, -1

    s_waitcnt vmcnt(0)
    s_mov_b64 exec, 1
    ds_add_u32 v28, v29 offset:12
    ds_add_u32 v28, v29 offset:28
    s_mov_b64 exec, -1

    v_lshlrev_b32 v31, 4, v1
    v_mov_b32 v21, 159768
L_c6_wl:
    ds_read_b32 v22, v21
    s_waitcnt lgkmcnt(0)
    v_readfirstlane_b32 s9, v22
    s_nop 0
    s_cmp_ge_u32 s9, 4
    s_cbranch_scc1 L_c6_wl_ok
    s_sleep 1
    s_add_u32 s13, s13, 1
    s_cmp_lt_u32 s13, 0x100000
    s_cbranch_scc1 L_c6_wl
L_c6_wl_ok:

    s_mov_b32 m0, 32768
    s_mov_b32 s9, 32768
    buffer_load_dwordx4 v31, s[52:55], s9 offen lds
    s_mov_b32 m0, 33792
    s_mov_b32 s9, 33792
    buffer_load_dwordx4 v31, s[52:55], s9 offen lds
    s_mov_b32 m0, 34816
    s_mov_b32 s9, 34816
    buffer_load_dwordx4 v31, s[52:55], s9 offen lds
    s_mov_b32 m0, 35840
    s_mov_b32 s9, 35840
    buffer_load_dwordx4 v31, s[52:55], s9 offen lds
    s_mov_b32 m0, 36864
    s_mov_b32 s9, 36864
    buffer_load_dwordx4 v31, s[52:55], s9 offen lds
    s_mov_b32 m0, 37888
    s_mov_b32 s9, 37888
    buffer_load_dwordx4 v31, s[52:55], s9 offen lds
    s_mov_b32 m0, 38912
    s_mov_b32 s9, 38912
    buffer_load_dwordx4 v31, s[52:55], s9 offen lds
    s_mov_b32 m0, 39936
    s_mov_b32 s9, 39936
    buffer_load_dwordx4 v31, s[52:55], s9 offen lds
    s_mov_b32 m0, 40960
    s_mov_b32 s9, 40960
    buffer_load_dwordx4 v31, s[52:55], s9 offen lds
    s_mov_b32 m0, 41984
    s_mov_b32 s9, 41984
    buffer_load_dwordx4 v31, s[52:55], s9 offen lds
    s_mov_b32 m0, 43008
    s_mov_b32 s9, 43008
    buffer_load_dwordx4 v31, s[52:55], s9 offen lds
    s_mov_b32 m0, 44032
    s_mov_b32 s9, 44032
    buffer_load_dwordx4 v31, s[52:55], s9 offen lds
    s_mov_b32 m0, 45056
    s_mov_b32 s9, 45056
    buffer_load_dwordx4 v31, s[52:55], s9 offen lds
    s_mov_b32 m0, 46080
    s_mov_b32 s9, 46080
    buffer_load_dwordx4 v31, s[52:55], s9 offen lds
    s_mov_b32 m0, 47104
    s_mov_b32 s9, 47104
    buffer_load_dwordx4 v31, s[52:55], s9 offen lds
    s_mov_b32 m0, 48128
    s_mov_b32 s9, 48128
    buffer_load_dwordx4 v31, s[52:55], s9 offen lds
    s_mov_b32 m0, 49152
    s_mov_b32 s9, 49152
    buffer_load_dwordx4 v31, s[52:55], s9 offen lds
    s_mov_b32 m0, 50176
    s_mov_b32 s9, 50176
    buffer_load_dwordx4 v31, s[52:55], s9 offen lds
    s_mov_b32 m0, 51200
    s_mov_b32 s9, 51200
    buffer_load_dwordx4 v31, s[52:55], s9 offen lds
    s_mov_b32 m0, 52224
    s_mov_b32 s9, 52224
    buffer_load_dwordx4 v31, s[52:55], s9 offen lds
    s_branch L_c_waitA2
L_c_w7:
    v_lshlrev_b32 v31, 4, v1
    v_mov_b32 v21, 159872
L_c_wq7:
    ds_read_b32 v22, v21
    s_waitcnt lgkmcnt(0)
    v_readfirstlane_b32 s9, v22
    s_nop 0
    s_cmp_ge_u32 s9, 4
    s_cbranch_scc1 L_c_wq7_ok
    s_sleep 1
    s_add_u32 s13, s13, 1
    s_cmp_lt_u32 s13, 0x100000
    s_cbranch_scc1 L_c_wq7
L_c_wq7_ok:

    v_lshrrev_b32 v20, 1, v1
    v_and_b32 v20, 15, v20
    v_lshrrev_b32 v21, 3, v20
    v_lshlrev_b32 v21, 4, v21
    v_and_b32 v22, 3, v20
    v_lshlrev_b32 v22, 2, v22
    v_add3_u32 v21, v21, v22, 3
    v_lshlrev_b32 v26, 10, v21
    v_lshrrev_b32 v22, 2, v20
    v_and_b32 v22, 1, v22
    v_lshlrev_b32 v22, 8, v22
    v_and_b32 v27, 1, v1
    v_lshlrev_b32 v27, 9, v27
    v_add3_u32 v26, v26, v22, v27
    v_add_u32 v30, 252, v26

    s_mov_b32 m0, 0
    s_mov_b32 s9, 0
    buffer_load_dwordx4 v31, s[56:59], s9 offen sc1 lds
    s_mov_b32 m0, 1024
    s_mov_b32 s9, 1024
    buffer_load_dwordx4 v31, s[56:59], s9 offen sc1 lds
    s_mov_b32 m0, 2048
    s_mov_b32 s9, 2048
    buffer_load_dwordx4 v31, s[56:59], s9 offen sc1 lds
    s_mov_b32 m0, 3072
    s_mov_b32 s9, 3072
    buffer_load_dwordx4 v31, s[56:59], s9 offen sc1 lds
    s_mov_b32 m0, 4096
    s_mov_b32 s9, 4096
    buffer_load_dwordx4 v31, s[56:59], s9 offen sc1 lds
    s_mov_b32 m0, 5120
    s_mov_b32 s9, 5120
    buffer_load_dwordx4 v31, s[56:59], s9 offen sc1 lds
    s_mov_b32 m0, 6144
    s_mov_b32 s9, 6144
    buffer_load_dwordx4 v31, s[56:59], s9 offen sc1 lds
    s_mov_b32 m0, 7168
    s_mov_b32 s9, 7168
    buffer_load_dwordx4 v31, s[56:59], s9 offen sc1 lds
    s_mov_b32 m0, 8192
    s_mov_b32 s9, 8192
    buffer_load_dwordx4 v31, s[56:59], s9 offen sc1 lds
    s_mov_b32 m0, 9216
    s_mov_b32 s9, 9216
    buffer_load_dwordx4 v31, s[56:59], s9 offen sc1 lds
    s_mov_b32 m0, 10240
    s_mov_b32 s9, 10240
    buffer_load_dwordx4 v31, s[56:59], s9 offen sc1 lds
    s_mov_b32 m0, 11264
    s_mov_b32 s9, 11264
    buffer_load_dwordx4 v31, s[56:59], s9 offen sc1 lds
    s_mov_b32 m0, 12288
    s_mov_b32 s9, 12288
    buffer_load_dwordx4 v31, s[56:59], s9 offen sc1 lds
    s_mov_b32 m0, 13312
    s_mov_b32 s9, 13312
    buffer_load_dwordx4 v31, s[56:59], s9 offen sc1 lds
    s_mov_b32 m0, 14336
    s_mov_b32 s9, 14336
    buffer_load_dwordx4 v31, s[56:59], s9 offen sc1 lds
    s_mov_b32 m0, 15360
    s_mov_b32 s9, 15360
    buffer_load_dwordx4 v31, s[56:59], s9 offen sc1 lds
    s_mov_b32 m0, 16384
    s_mov_b32 s9, 16384
    buffer_load_dwordx4 v31, s[56:59], s9 offen sc1 lds
    s_mov_b32 m0, 17408
    s_mov_b32 s9, 17408
    buffer_load_dwordx4 v31, s[56:59], s9 offen sc1 lds
    s_mov_b32 m0, 18432
    s_mov_b32 s9, 18432
    buffer_load_dwordx4 v31, s[56:59], s9 offen sc1 lds
    s_mov_b32 m0, 19456
    s_mov_b32 s9, 19456
    buffer_load_dwordx4 v31, s[56:59], s9 offen sc1 lds
    s_mov_b32 m0, 20480
    s_mov_b32 s9, 20480
    buffer_load_dwordx4 v31, s[56:59], s9 offen sc1 lds
    s_mov_b32 m0, 21504
    s_mov_b32 s9, 21504
    buffer_load_dwordx4 v31, s[56:59], s9 offen sc1 lds
    s_mov_b32 m0, 22528
    s_mov_b32 s9, 22528
    buffer_load_dwordx4 v31, s[56:59], s9 offen sc1 lds
    s_mov_b32 m0, 23552
    s_mov_b32 s9, 23552
    buffer_load_dwordx4 v31, s[56:59], s9 offen sc1 lds
    v_mov_b32 v21, 159876
    v_mov_b32 v22, 1
    s_mov_b64 exec, 1
    ds_write_b32 v21, v22
    s_mov_b64 exec, -1
    s_waitcnt vmcnt(33)
    s_mov_b64 exec, 1
    ds_add_u32 v28, v29 offset:0
    ds_add_u32 v28, v29 offset:16
    s_mov_b64 exec, -1

    s_add_u32 m0, s61, 43008
    s_add_u32 s11, s60, 86016
    buffer_load_dwordx4 v32, s[40:43], s11 offen nt lds
    s_add_u32 m0, s61, 44032
    s_add_u32 s11, s60, 86016
    buffer_load_dwordx4 v33, s[40:43], s11 offen nt lds
    s_add_u32 m0, s61, 45056
    s_add_u32 s11, s60, 86016
    buffer_load_dwordx4 v34, s[40:43], s11 offen nt lds
    s_add_u32 m0, s61, 46080
    s_add_u32 s11, s60, 92160
    buffer_load_dwordx4 v35, s[40:43], s11 offen nt lds
    s_add_u32 m0, s61, 47104
    s_add_u32 s11, s60, 92160
    buffer_load_dwordx4 v36, s[40:43], s11 offen nt lds
    s_add_u32 m0, s61, 48128
    s_add_u32 s11, s60, 92160
    buffer_load_dwordx4 v37, s[40:43], s11 offen nt lds
    s_add_u32 m0, s61, 49152
    s_add_u32 s11, s60, 98304
    buffer_load_dwordx4 v32, s[40:43], s11 offen nt lds
    s_add_u32 m0, s61, 50176
    s_add_u32 s11, s60, 98304
    buffer_load_dwordx4 v33, s[40:43], s11 offen nt lds
    s_add_u32 m0, s61, 51200
    s_add_u32 s11, s60, 98304
    buffer_load_dwordx4 v34, s[40:43], s11 offen nt lds
    s_waitcnt vmcnt(33)
    s_mov_b64 exec, 1
    ds_add_u32 v28, v29 offset:4
    ds_add_u32 v28, v29 offset:20
    s_mov_b64 exec, -1

    v_mov_b32 v21, 159880
L_c_wq7b:
    ds_read_b32 v22, v21
    s_waitcnt lgkmcnt(0)
    v_readfirstlane_b32 s9, v22
    s_nop 0
    s_cmp_ge_u32 s9, 4
    s_cbranch_scc1 L_c_wq7b_ok
    s_sleep 1
    s_add_u32 s13, s13, 1
    s_cmp_lt_u32 s13, 0x100000
    s_cbranch_scc1 L_c_wq7b
L_c_wq7b_ok:

    s_mov_b32 m0, 24576
    s_mov_b32 s9, 24576
    buffer_load_dwordx4 v31, s[56:59], s9 offen sc1 lds
    s_mov_b32 m0, 25600
    s_mov_b32 s9, 25600
    buffer_load_dwordx4 v31, s[56:59], s9 offen sc1 lds
    s_mov_b32 m0, 26624
    s_mov_b32 s9, 26624
    buffer_load_dwordx4 v31, s[56:59], s9 offen sc1 lds
    s_mov_b32 m0, 27648
    s_mov_b32 s9, 27648
    buffer_load_dwordx4 v31, s[56:59], s9 offen sc1 lds
    s_mov_b32 m0, 28672
    s_mov_b32 s9, 28672
    buffer_load_dwordx4 v31, s[56:59], s9 offen sc1 lds
    s_mov_b32 m0, 29696
    s_mov_b32 s9, 29696
    buffer_load_dwordx4 v31, s[56:59], s9 offen sc1 lds
    s_mov_b32 m0, 30720
    s_mov_b32 s9, 30720
    buffer_load_dwordx4 v31, s[56:59], s9 offen sc1 lds
    s_mov_b32 m0, 31744
    s_mov_b32 s9, 31744
    buffer_load_dwordx4 v31, s[56:59], s9 offen sc1 lds
    s_waitcnt vmcnt(17)
    v_mov_b32 v21, 159760
    v_mov_b32 v22, 1
    s_mov_b64 exec, 1
    ds_write_b32 v21, v22
    s_mov_b64 exec, -1
    v_mov_b32 v21, 159792
L_c7_wf0:
    ds_read_b32 v22, v21
    s_waitcnt lgkmcnt(0)
    v_readfirstlane_b32 s9, v22
    s_nop 0
    s_cmp_ge_u32 s9, 1
    s_cbranch_scc1 L_c7_wf0_ok
    s_sleep 1
    s_add_u32 s13, s13, 1
    s_cmp_lt_u32 s13, 0x100000
    s_cbranch_scc1 L_c7_wf0
L_c7_wf0_ok:

    v_mov_b32 v21, 159796
L_c7_wf1:
    ds_read_b32 v22, v21
    s_waitcnt lgkmcnt(0)
    v_readfirstlane_b32 s9, v22
    s_nop 0
    s_cmp_ge_u32 s9, 1
    s_cbranch_scc1 L_c7_wf1_ok
    s_sleep 1
    s_add_u32 s13, s13, 1
    s_cmp_lt_u32 s13, 0x100000
    s_cbranch_scc1 L_c7_wf1
L_c7_wf1_ok:

    v_mov_b32 v21, 159800
L_c7_wf2:
    ds_read_b32 v22, v21
    s_waitcnt lgkmcnt(0)
    v_readfirstlane_b32 s9, v22
    s_nop 0
    s_cmp_ge_u32 s9, 1
    s_cbranch_scc1 L_c7_wf2_ok
    s_sleep 1
    s_add_u32 s13, s13, 1
    s_cmp_lt_u32 s13, 0x100000
    s_cbranch_scc1 L_c7_wf2
L_c7_wf2_ok:

    v_mov_b32 v21, 159804
L_c7_wf3:
    ds_read_b32 v22, v21
    s_waitcnt lgkmcnt(0)
    v_readfirstlane_b32 s9, v22
    s_nop 0
    s_cmp_ge_u32 s9, 1
    s_cbranch_scc1 L_c7_wf3_ok
    s_sleep 1
    s_add_u32 s13, s13, 1
    s_cmp_lt_u32 s13, 0x100000
    s_cbranch_scc1 L_c7_wf3
L_c7_wf3_ok:

    s_add_u32 m0, s61, 64512
    s_add_u32 s11, s60, 86400
    buffer_load_dwordx4 v35, s[40:43], s11 offen nt lds
    s_add_u32 m0, s61, 65536
    s_add_u32 s11, s60, 86400
    buffer_load_dwordx4 v36, s[40:43], s11 offen nt lds
    s_add_u32 m0, s61, 66560
    s_add_u32 s11, s60, 86400
    buffer_load_dwordx4 v37, s[40:43], s11 offen nt lds
    s_add_u32 m0, s61, 67584
    s_add_u32 s11, s60, 92544
    buffer_load_dwordx4 v32, s[40:43], s11 offen nt lds
    s_add_u32 m0, s61, 68608
    s_add_u32 s11, s60, 92544
    buffer_load_dwordx4 v33, s[40:43], s11 offen nt lds
    s_add_u32 m0, s61, 69632
    s_add_u32 s11, s60, 92544
    buffer_load_dwordx4 v34, s[40:43], s11 offen nt lds
    s_add_u32 m0, s61, 70656
    s_add_u32 s11, s60, 98688
    buffer_load_dwordx4 v35, s[40:43], s11 offen nt lds
    s_add_u32 m0, s61, 71680
    s_add_u32 s11, s60, 98688
    buffer_load_dwordx4 v36, s[40:43], s11 offen nt lds
    s_add_u32 m0, s61, 72704
    s_add_u32 s11, s60, 98688
    buffer_load_dwordx4 v37, s[40:43], s11 offen nt lds
    s_waitcnt vmcnt(17)
    s_mov_b64 exec, 1
    ds_add_u32 v28, v29 offset:8
    ds_add_u32 v28, v29 offset:24
    s_mov_b64 exec, -1

    s_waitcnt vmcnt(9)
    s_mov_b32 s62, 0
L_c_st_chk:
    ds_read_b32 v22, v30
    s_waitcnt lgkmcnt(0)
    v_cmp_ne_u32 vcc, s90, v22
    s_add_u32 s62, s62, 1
    s_cbranch_vccz L_c_st_ok
    s_cmp_lt_u32 s62, 0x400
    s_cbranch_scc0 L_c_st_ok

    s_mov_b32 m0, 16384
    s_mov_b32 s9, 16384
    buffer_load_dwordx4 v31, s[56:59], s9 offen sc1 lds
    s_mov_b32 m0, 17408
    s_mov_b32 s9, 17408
    buffer_load_dwordx4 v31, s[56:59], s9 offen sc1 lds
    s_mov_b32 m0, 18432
    s_mov_b32 s9, 18432
    buffer_load_dwordx4 v31, s[56:59], s9 offen sc1 lds
    s_mov_b32 m0, 19456
    s_mov_b32 s9, 19456
    buffer_load_dwordx4 v31, s[56:59], s9 offen sc1 lds
    s_mov_b32 m0, 20480
    s_mov_b32 s9, 20480
    buffer_load_dwordx4 v31, s[56:59], s9 offen sc1 lds
    s_mov_b32 m0, 21504
    s_mov_b32 s9, 21504
    buffer_load_dwordx4 v31, s[56:59], s9 offen sc1 lds
    s_mov_b32 m0, 22528
    s_mov_b32 s9, 22528
    buffer_load_dwordx4 v31, s[56:59], s9 offen sc1 lds
    s_mov_b32 m0, 23552
    s_mov_b32 s9, 23552
    buffer_load_dwordx4 v31, s[56:59], s9 offen sc1 lds
    s_mov_b32 m0, 24576
    s_mov_b32 s9, 24576
    buffer_load_dwordx4 v31, s[56:59], s9 offen sc1 lds
    s_mov_b32 m0, 25600
    s_mov_b32 s9, 25600
    buffer_load_dwordx4 v31, s[56:59], s9 offen sc1 lds
    s_mov_b32 m0, 26624
    s_mov_b32 s9, 26624
    buffer_load_dwordx4 v31, s[56:59], s9 offen sc1 lds
    s_mov_b32 m0, 27648
    s_mov_b32 s9, 27648
    buffer_load_dwordx4 v31, s[56:59], s9 offen sc1 lds
    s_mov_b32 m0, 28672
    s_mov_b32 s9, 28672
    buffer_load_dwordx4 v31, s[56:59], s9 offen sc1 lds
    s_mov_b32 m0, 29696
    s_mov_b32 s9, 29696
    buffer_load_dwordx4 v31, s[56:59], s9 offen sc1 lds
    s_mov_b32 m0, 30720
    s_mov_b32 s9, 30720
    buffer_load_dwordx4 v31, s[56:59], s9 offen sc1 lds
    s_mov_b32 m0, 31744
    s_mov_b32 s9, 31744
    buffer_load_dwordx4 v31, s[56:59], s9 offen sc1 lds
    v_or_b32 v30, 0, v30
    s_waitcnt vmcnt(0)
    s_cmp_lt_u32 s62, 2
    s_cbranch_scc1 L_c_st_chk
L_c_st_ok:

    v_mov_b32 v21, 159884
    v_mov_b32 v22, 1
    s_mov_b64 exec, 1
    ds_write_b32 v21, v22
    s_mov_b64 exec, -1
    s_waitcnt vmcnt(0)
    s_mov_b64 exec, 1
    ds_add_u32 v28, v29 offset:12
    ds_add_u32 v28, v29 offset:28
    s_mov_b64 exec, -1

    v_lshlrev_b32 v20, 4, v1
    s_lshl_b32 s9, s5, 14
    v_add_u32 v20, s9, v20
    ds_read_b128 v[176:179], v20 offset:0
    ds_read_b128 v[180:183], v20 offset:1024
    ds_read_b128 v[184:187], v20 offset:2048
    ds_read_b128 v[188:191], v20 offset:3072
    ds_read_b128 v[192:195], v20 offset:4096
    ds_read_b128 v[196:199], v20 offset:5120
    ds_read_b128 v[200:203], v20 offset:6144
    ds_read_b128 v[204:207], v20 offset:7168
    ds_read_b128 v[208:211], v20 offset:8192
    ds_read_b128 v[212:215], v20 offset:9216
    ds_read_b128 v[216:219], v20 offset:10240
    ds_read_b128 v[220:223], v20 offset:11264
    ds_read_b128 v[224:227], v20 offset:12288
    ds_read_b128 v[228:231], v20 offset:13312
    s_waitcnt lgkmcnt(8)
    ds_read_b128 v[232:235], v20 offset:14336
    ds_read_b128 v[236:239], v20 offset:15360
    v_mov_b32 v21, 159772
    v_mov_b32 v22, 1
    s_waitcnt lgkmcnt(0)
    s_mov_b64 exec, 1
    ds_add_u32 v21, v22
    s_mov_b64 exec, -1

    v_lshlrev_b32 v31, 4, v1
    v_mov_b32 v21, 159768
L_c7_wl:
    ds_read_b32 v22, v21
    s_waitcnt lgkmcnt(0)
    v_readfirstlane_b32 s9, v22
    s_nop 0
    s_cmp_ge_u32 s9, 4
    s_cbranch_scc1 L_c7_wl_ok
    s_sleep 1
    s_add_u32 s13, s13, 1
    s_cmp_lt_u32 s13, 0x100000
    s_cbranch_scc1 L_c7_wl
L_c7_wl_ok:

    s_mov_b32 m0, 53248
    s_mov_b32 s9, 53248
    buffer_load_dwordx4 v31, s[52:55], s9 offen lds
    s_mov_b32 m0, 54272
    s_mov_b32 s9, 54272
    buffer_load_dwordx4 v31, s[52:55], s9 offen lds
    s_mov_b32 m0, 55296
    s_mov_b32 s9, 55296
    buffer_load_dwordx4 v31, s[52:55], s9 offen lds
    s_mov_b32 m0, 56320
    s_mov_b32 s9, 56320
    buffer_load_dwordx4 v31, s[52:55], s9 offen lds
    s_mov_b32 m0, 57344
    s_mov_b32 s9, 57344
    buffer_load_dwordx4 v31, s[52:55], s9 offen lds
    s_mov_b32 m0, 58368
    s_mov_b32 s9, 58368
    buffer_load_dwordx4 v31, s[52:55], s9 offen lds
    s_mov_b32 m0, 59392
    s_mov_b32 s9, 59392
    buffer_load_dwordx4 v31, s[52:55], s9 offen lds
    s_mov_b32 m0, 60416
    s_mov_b32 s9, 60416
    buffer_load_dwordx4 v31, s[52:55], s9 offen lds
    s_mov_b32 m0, 61440
    s_mov_b32 s9, 61440
    buffer_load_dwordx4 v31, s[52:55], s9 offen lds
    s_mov_b32 m0, 62464
    s_mov_b32 s9, 62464
    buffer_load_dwordx4 v31, s[52:55], s9 offen lds
    s_mov_b32 m0, 63488
    s_mov_b32 s9, 63488
    buffer_load_dwordx4 v31, s[52:55], s9 offen lds
    s_mov_b32 m0, 64512
    s_mov_b32 s9, 64512
    buffer_load_dwordx4 v31, s[52:55], s9 offen lds
    s_mov_b32 m0, 65536
    s_mov_b32 s9, 65536
    buffer_load_dwordx4 v31, s[52:55], s9 offen lds
    s_mov_b32 m0, 66560
    s_mov_b32 s9, 66560
    buffer_load_dwordx4 v31, s[52:55], s9 offen lds
    s_mov_b32 m0, 67584
    s_mov_b32 s9, 67584
    buffer_load_dwordx4 v31, s[52:55], s9 offen lds
    s_mov_b32 m0, 68608
    s_mov_b32 s9, 68608
    buffer_load_dwordx4 v31, s[52:55], s9 offen lds
    s_mov_b32 m0, 69632
    s_mov_b32 s9, 69632
    buffer_load_dwordx4 v31, s[52:55], s9 offen lds
    s_mov_b32 m0, 70656
    s_mov_b32 s9, 70656
    buffer_load_dwordx4 v31, s[52:55], s9 offen lds
    s_mov_b32 m0, 71680
    s_mov_b32 s9, 71680
    buffer_load_dwordx4 v31, s[52:55], s9 offen lds
    s_mov_b32 m0, 72704
    s_mov_b32 s9, 72704
    buffer_load_dwordx4 v31, s[52:55], s9 offen lds
    s_branch L_c_chkA
L_c_waitA:
L_c_waitA2:
    s_mul_i32 s9, s5, 124
    s_add_u32 s9, s9, 159760
    v_mov_b32 v21, s9

L_c_spA:
    ds_read_b32 v22, v21
    s_waitcnt lgkmcnt(0)
    v_readfirstlane_b32 s9, v22
    s_nop 0
    s_cmp_ge_u32 s9, 1
    s_cbranch_scc1 L_c_spA_ok
    s_sleep 1
    s_add_u32 s13, s13, 1
    s_cmp_lt_u32 s13, 0x100000
    s_cbranch_scc1 L_c_spA
L_c_spA_ok:

    v_lshlrev_b32 v20, 4, v1
    s_lshl_b32 s9, s5, 14
    v_add_u32 v20, s9, v20
    ds_read_b128 v[176:179], v20 offset:0
    ds_read_b128 v[180:183], v20 offset:1024
    ds_read_b128 v[184:187], v20 offset:2048
    ds_read_b128 v[188:191], v20 offset:3072
    ds_read_b128 v[192:195], v20 offset:4096
    ds_read_b128 v[196:199], v20 offset:5120
    ds_read_b128 v[200:203], v20 offset:6144
    ds_read_b128 v[204:207], v20 offset:7168
    ds_read_b128 v[208:211], v20 offset:8192
    ds_read_b128 v[212:215], v20 offset:9216
    ds_read_b128 v[216:219], v20 offset:10240
    ds_read_b128 v[220:223], v20 offset:11264
    ds_read_b128 v[224:227], v20 offset:12288
    ds_read_b128 v[228:231], v20 offset:13312
    s_waitcnt lgkmcnt(8)
    ds_read_b128 v[232:235], v20 offset:14336
    ds_read_b128 v[236:239], v20 offset:15360
    v_mov_b32 v21, 159772
    v_mov_b32 v22, 1
    s_waitcnt lgkmcnt(0)
    s_mov_b64 exec, 1
    ds_add_u32 v21, v22
    s_mov_b64 exec, -1

    s_branch L_c_chkA
L_c_reloadA:

    v_lshlrev_b32 v20, 4, v1
    s_lshl_b32 s9, s5, 14
    s_add_u32 s9, s9, 0
    buffer_load_dwordx4 v[176:179], v20, s[56:59], s9 offen offset:0 sc1
    buffer_load_dwordx4 v[180:183], v20, s[56:59], s9 offen offset:1024 sc1
    buffer_load_dwordx4 v[184:187], v20, s[56:59], s9 offen offset:2048 sc1
    buffer_load_dwordx4 v[188:191], v20, s[56:59], s9 offen offset:3072 sc1
    s_add_u32 s9, s9, 4096
    buffer_load_dwordx4 v[192:195], v20, s[56:59], s9 offen offset:0 sc1
    buffer_load_dwordx4 v[196:199], v20, s[56:59], s9 offen offset:1024 sc1
    buffer_load_dwordx4 v[200:203], v20, s[56:59], s9 offen offset:2048 sc1
    buffer_load_dwordx4 v[204:207], v20, s[56:59], s9 offen offset:3072 sc1
    s_add_u32 s9, s9, 4096
    buffer_load_dwordx4 v[208:211], v20, s[56:59], s9 offen offset:0 sc1
    buffer_load_dwordx4 v[212:215], v20, s[56:59], s9 offen offset:1024 sc1
    buffer_load_dwordx4 v[216:219], v20, s[56:59], s9 offen offset:2048 sc1
    buffer_load_dwordx4 v[220:223], v20, s[56:59], s9 offen offset:3072 sc1
    s_add_u32 s9, s9, 4096
    buffer_load_dwordx4 v[224:227], v20, s[56:59], s9 offen offset:0 sc1
    buffer_load_dwordx4 v[228:231], v20, s[56:59], s9 offen offset:1024 sc1
    buffer_load_dwordx4 v[232:235], v20, s[56:59], s9 offen offset:2048 sc1
    buffer_load_dwordx4 v[236:239], v20, s[56:59], s9 offen offset:3072 sc1
    s_waitcnt vmcnt(0)
L_c_chkA:
    v_xor_b32 v20, s90, v179
    v_xor_b32 v21, s90, v183
    v_xor_b32 v22, s90, v187
    v_or3_b32 v20, v20, v21, v22
    v_xor_b32 v21, s90, v191
    v_xor_b32 v22, s90, v195
    v_or3_b32 v20, v20, v21, v22
    v_xor_b32 v21, s90, v199
    v_xor_b32 v22, s90, v203
    v_or3_b32 v20, v20, v21, v22
    v_xor_b32 v21, s90, v207
    v_xor_b32 v22, s90, v211
    v_or3_b32 v20, v20, v21, v22
    v_xor_b32 v21, s90, v215
    v_xor_b32 v22, s90, v219
    v_or3_b32 v20, v20, v21, v22
    v_xor_b32 v21, s90, v223
    v_xor_b32 v22, s90, v227
    v_or3_b32 v20, v20, v21, v22
    v_xor_b32 v21, s90, v231
    v_xor_b32 v22, s90, v235
    v_or3_b32 v20, v20, v21, v22
    v_xor_b32 v21, s90, v239
    v_or_b32 v20, v20, v21
    v_cmp_ne_u32 vcc, 0, v20
    s_cbranch_vccz L_c_haveA
    s_add_u32 s13, s13, 1
    s_cmp_lt_u32 s13, 0x1000
    s_cbranch_scc0 L_c_haveA
    s_branch L_c_reloadA

L_c_haveA:
    v_mov_b32 v32, v176
    v_mov_b32 v33, v177
    v_mov_b32 v34, v178
    v_mov_b32 v35, v180
    v_mov_b32 v36, v181
    v_mov_b32 v37, v182
    v_mov_b32 v38, v184
    v_mov_b32 v39, v185
    v_mov_b32 v40, v186
    v_mov_b32 v41, v188
    v_mov_b32 v42, v189
    v_mov_b32 v43, v190
    v_mov_b32 v44, v192
    v_mov_b32 v45, v193
    v_mov_b32 v46, v194
    v_mov_b32 v47, v196
    v_mov_b32 v48, v197
    v_mov_b32 v49, v198
    v_mov_b32 v50, v200
    v_mov_b32 v51, v201
    v_mov_b32 v52, v202
    v_mov_b32 v53, v204
    v_mov_b32 v54, v205
    v_mov_b32 v55, v206
    v_mov_b32 v56, v208
    v_mov_b32 v57, v209
    v_mov_b32 v58, v210
    v_mov_b32 v59, v212
    v_mov_b32 v60, v213
    v_mov_b32 v61, v214
    v_mov_b32 v62, v216
    v_mov_b32 v63, v217
    v_mov_b32 v64, v218
    v_mov_b32 v65, v220
    v_mov_b32 v66, v221
    v_mov_b32 v67, v222
    v_mov_b32 v68, v224
    v_mov_b32 v69, v225
    v_mov_b32 v70, v226
    v_mov_b32 v71, v228
    v_mov_b32 v72, v229
    v_mov_b32 v73, v230
    v_mov_b32 v74, v232
    v_mov_b32 v75, v233
    v_mov_b32 v76, v234
    v_mov_b32 v77, v236
    v_mov_b32 v78, v237
    v_mov_b32 v79, v238
    v_mov_b32 v208, 0
    v_mov_b32 v209, 0
    v_mov_b32 v210, 0
    v_mov_b32 v211, 0
    v_mov_b32 v212, 0
    v_mov_b32 v213, 0
    v_mov_b32 v214, 0
    v_mov_b32 v215, 0
    v_mov_b32 v216, 0
    v_mov_b32 v217, 0
    v_mov_b32 v218, 0
    v_mov_b32 v219, 0
    v_mov_b32 v220, 0
    v_mov_b32 v221, 0
    v_mov_b32 v222, 0
    v_mov_b32 v223, 0
    v_lshrrev_b32 v20, 4, v1
    v_and_b32 v20, 1, v20
    v_and_b32 v22, 15, v1
    v_cmp_eq_u32 vcc, v20, v22
    v_mov_b32 v22, 0x3f803f80
    s_nop 0
    v_cndmask_b32 v252, 0, v22, vcc
    v_cndmask_b32 v253, 0, v22, vcc
    v_cndmask_b32 v254, 0, v22, vcc
    v_cndmask_b32 v255, 0, v22, vcc
    v_mov_b32 v248, 0
    v_mov_b32 v249, 0
    v_mov_b32 v250, 0
    v_mov_b32 v251, 0
    s_sub_u32 s10, 4, s6
    s_lshl_b32 s9, s6, 2
    s_add_u32 s9, s9, 159744
    v_mov_b32 v21, s9

L_c_wt0:
    ds_read_b32 v22, v21
    s_waitcnt lgkmcnt(0)
    v_readfirstlane_b32 s9, v22
    s_nop 0
    s_cmp_ge_u32 s9, 4
    s_cbranch_scc1 L_c_wt0_ok
    s_sleep 1
    s_add_u32 s13, s13, 1
    s_cmp_lt_u32 s13, 0x100000
    s_cbranch_scc1 L_c_wt0
L_c_wt0_ok:

    ds_read_b128 v[224:227], v8 offset:0
    ds_read_b128 v[228:231], v9 offset:0
    ds_read_b128 v[232:235], v10 offset:0
    ds_read_b128 v[236:239], v11 offset:0
    ds_read_b128 v[240:243], v8 offset:128
    s_waitcnt lgkmcnt(4)
    v_mfma_f32_32x32x16_bf16 v[176:191], v[224:227], v[32:35], v[208:223]
    ds_read_b128 v[244:247], v9 offset:128
    s_waitcnt lgkmcnt(4)
    v_mfma_f32_32x32x16_bf16 v[176:191], v[228:231], v[36:39], v[176:191]
    ds_read_b128 v[224:227], v10 offset:128
    s_waitcnt lgkmcnt(4)
    v_mfma_f32_32x32x16_bf16 v[176:191], v[232:235], v[40:43], v[176:191]
    ds_read_b128 v[228:231], v11 offset:128
    s_waitcnt lgkmcnt(4)
    v_mfma_f32_32x32x16_bf16 v[176:191], v[236:239], v[44:47], v[176:191]
    ds_read_b128 v[232:235], v8 offset:256
    s_waitcnt lgkmcnt(4)
    v_mfma_f32_32x32x16_bf16 v[176:191], v[240:243], v[48:51], v[176:191]
    ds_read_b128 v[236:239], v9 offset:256
    s_waitcnt lgkmcnt(4)
    v_mfma_f32_32x32x16_bf16 v[176:191], v[244:247], v[52:55], v[176:191]
    ds_read_b128 v[240:243], v10 offset:256
    s_waitcnt lgkmcnt(4)
    v_mfma_f32_32x32x16_bf16 v[176:191], v[224:227], v[56:59], v[176:191]
    ds_read_b128 v[244:247], v11 offset:256
    s_waitcnt lgkmcnt(4)
    v_mfma_f32_32x32x16_bf16 v[176:191], v[228:231], v[60:63], v[176:191]
    s_waitcnt lgkmcnt(3)
    v_mfma_f32_32x32x16_bf16 v[176:191], v[232:235], v[64:67], v[176:191]
    s_waitcnt lgkmcnt(2)
    v_mfma_f32_32x32x16_bf16 v[176:191], v[236:239], v[68:71], v[176:191]
    s_waitcnt lgkmcnt(1)
    v_mfma_f32_32x32x16_bf16 v[176:191], v[240:243], v[72:75], v[176:191]
    s_waitcnt lgkmcnt(0)
    v_mfma_f32_32x32x16_bf16 v[176:191], v[244:247], v[76:79], v[176:191]
    v_add_u32 v8, 24576, v8
    v_add_u32 v9, 24576, v9
    v_add_u32 v10, 24576, v10
    v_add_u32 v11, 24576, v11
    v_add_u32 v21, 4, v21
    s_nop 6
    v_max3_f32 v18, v176, v177, v178
    v_max3_f32 v18, v18, v179, v180
    v_max3_f32 v18, v18, v181, v182
    v_max3_f32 v18, v18, v183, v184
    v_max3_f32 v18, v18, v185, v186
    v_max3_f32 v18, v18, v187, v188
    v_max3_f32 v18, v18, v189, v190
    v_max_f32 v18, v18, v191
    v_mov_b32 v19, v18
    s_nop 1
    v_permlane32_swap_b32 v19, v18
    v_max_f32 v18, v18, v19

    v_add_f32 v17, v17, v18
    v_sub_f32 v176, v176, v18
    v_sub_f32 v177, v177, v18
    v_sub_f32 v178, v178, v18
    v_sub_f32 v179, v179, v18
    v_sub_f32 v180, v180, v18
    v_sub_f32 v181, v181, v18
    v_sub_f32 v182, v182, v18
    v_sub_f32 v183, v183, v18
    v_sub_f32 v184, v184, v18
    v_sub_f32 v185, v185, v18
    v_sub_f32 v186, v186, v18
    v_sub_f32 v187, v187, v18
    v_sub_f32 v188, v188, v18
    v_sub_f32 v189, v189, v18
    v_sub_f32 v190, v190, v18
    v_sub_f32 v191, v191, v18
    v_sub_f32 v208, v208, v18
    v_sub_f32 v209, v209, v18
    v_sub_f32 v210, v210, v18
    v_sub_f32 v211, v211, v18
    v_sub_f32 v212, v212, v18
    v_sub_f32 v213, v213, v18
    v_sub_f32 v214, v214, v18
    v_sub_f32 v215, v215, v18
    v_sub_f32 v216, v216, v18
    v_sub_f32 v217, v217, v18
    v_sub_f32 v218, v218, v18
    v_sub_f32 v219, v219, v18
    v_sub_f32 v220, v220, v18
    v_sub_f32 v221, v221, v18
    v_sub_f32 v222, v222, v18
    v_sub_f32 v223, v223, v18
    v_exp_f32 v176, v176
    v_exp_f32 v177, v177
    v_exp_f32 v178, v178
    v_exp_f32 v179, v179
    v_exp_f32 v180, v180
    v_exp_f32 v181, v181
    v_exp_f32 v182, v182
    v_exp_f32 v183, v183
L_c_wt1:
    ds_read_b32 v22, v21
    s_waitcnt lgkmcnt(0)
    v_readfirstlane_b32 s9, v22
    s_nop 0
    s_cmp_ge_u32 s9, 4
    s_cbranch_scc1 L_c_wt1_ok
    s_sleep 1
    s_add_u32 s13, s13, 1
    s_cmp_lt_u32 s13, 0x100000
    s_cbranch_scc1 L_c_wt1
L_c_wt1_ok:

    ds_read_b128 v[224:227], v8 offset:0
    ds_read_b128 v[228:231], v9 offset:0
    ds_read_b128 v[232:235], v10 offset:0
    ds_read_b128 v[236:239], v11 offset:0
    ds_read_b128 v[240:243], v8 offset:128
    v_add_u32 v21, 4, v21
    s_mov_b32 s14, 0
L_c_it0:
    s_add_u32 s14, s14, 1
    s_cmp_lt_u32 s14, s10
    s_cbranch_scc0 L_c_last0

    s_waitcnt lgkmcnt(3)
    v_mfma_f32_32x32x16_bf16 v[192:207], v[224:227], v[32:35], v[208:223]
    ds_read_b128 v[244:247], v9 offset:128
    v_exp_f32 v184, v184
    v_exp_f32 v185, v185
    v_mfma_f32_32x32x16_bf16 v[192:207], v[228:231], v[36:39], v[192:207]
    ds_read_b128 v[224:227], v10 offset:128
    v_exp_f32 v186, v186
    v_exp_f32 v187, v187
    s_waitcnt lgkmcnt(3)
    v_mfma_f32_32x32x16_bf16 v[192:207], v[232:235], v[40:43], v[192:207]
    ds_read_b128 v[228:231], v11 offset:128
    v_exp_f32 v188, v188
    v_exp_f32 v189, v189
    v_mfma_f32_32x32x16_bf16 v[192:207], v[236:239], v[44:47], v[192:207]
    ds_read_b128 v[232:235], v8 offset:256
    v_exp_f32 v190, v190
    v_exp_f32 v191, v191
    s_waitcnt lgkmcnt(3)
    v_mfma_f32_32x32x16_bf16 v[192:207], v[240:243], v[48:51], v[192:207]
    ds_read_b128 v[236:239], v9 offset:256
    v_cvt_pk_bf16_f32 v24, v176, v177
    v_cvt_pk_bf16_f32 v25, v178, v179
    v_mfma_f32_32x32x16_bf16 v[192:207], v[244:247], v[52:55], v[192:207]
    ds_read_b128 v[240:243], v10 offset:256
    v_cvt_pk_bf16_f32 v26, v180, v181
    v_cvt_pk_bf16_f32 v27, v182, v183
    s_waitcnt lgkmcnt(3)
    v_mfma_f32_32x32x16_bf16 v[192:207], v[224:227], v[56:59], v[192:207]
    ds_read_b128 v[244:247], v11 offset:256
    v_cvt_pk_bf16_f32 v28, v184, v185
    v_cvt_pk_bf16_f32 v29, v186, v187
    v_mfma_f32_32x32x16_bf16 v[192:207], v[228:231], v[60:63], v[192:207]
    ds_read_b64_tr_b16 v[224:225], v12 offset:0
    ds_read_b64_tr_b16 v[226:227], v13 offset:3072
    v_cvt_pk_bf16_f32 v30, v188, v189
    v_cvt_pk_bf16_f32 v31, v190, v191
    v_add_u32 v8, 24576, v8
    v_add_u32 v9, 24576, v9
    v_add_u32 v10, 24576, v10
    v_add_u32 v11, 24576, v11
    s_waitcnt lgkmcnt(4)
    v_mfma_f32_32x32x16_bf16 v[192:207], v[232:235], v[64:67], v[192:207]
    ds_read_b64_tr_b16 v[228:229], v14 offset:0
    ds_read_b64_tr_b16 v[230:231], v15 offset:3072
    v_mfma_f32_32x32x16_bf16 v[192:207], v[236:239], v[68:71], v[192:207]
    ds_read_b64_tr_b16 v[232:233], v12 offset:128
    ds_read_b64_tr_b16 v[234:235], v13 offset:3200
    s_waitcnt lgkmcnt(6)
    v_mfma_f32_32x32x16_bf16 v[192:207], v[240:243], v[72:75], v[192:207]
    ds_read_b64_tr_b16 v[236:237], v14 offset:128
    ds_read_b64_tr_b16 v[238:239], v15 offset:3200
    v_mfma_f32_32x32x16_bf16 v[192:207], v[244:247], v[76:79], v[192:207]
    ds_read_b64_tr_b16 v[240:241], v12 offset:256
    ds_read_b64_tr_b16 v[242:243], v13 offset:3328
    ds_read_b32 v22, v21
    s_waitcnt lgkmcnt(7)
    v_mfma_f32_32x32x16_bf16 v[80:95], v[224:227], v[24:27], v[80:95]
    ds_read_b64_tr_b16 v[244:245], v14 offset:256
    ds_read_b64_tr_b16 v[246:247], v15 offset:3328
    s_nop 4
    v_max3_f32 v18, v192, v193, v194
    v_max3_f32 v18, v18, v195, v196
    v_max3_f32 v18, v18, v197, v198
    v_mfma_f32_32x32x16_bf16 v[96:111], v[228:231], v[24:27], v[96:111]
    ds_read_b64_tr_b16 v[224:225], v12 offset:6144
    ds_read_b64_tr_b16 v[226:227], v13 offset:9216
    v_max3_f32 v18, v18, v199, v200
    v_max3_f32 v18, v18, v201, v202
    v_max3_f32 v18, v18, v203, v204
    s_waitcnt lgkmcnt(7)
    v_mfma_f32_32x32x16_bf16 v[112:127], v[232:235], v[24:27], v[112:127]
    ds_read_b64_tr_b16 v[228:229], v14 offset:6144
    ds_read_b64_tr_b16 v[230:231], v15 offset:9216
    v_max3_f32 v18, v18, v205, v206
    v_max_f32 v18, v18, v207
    v_mfma_f32_32x32x16_bf16 v[128:143], v[236:239], v[24:27], v[128:143]
    ds_read_b64_tr_b16 v[232:233], v12 offset:6272
    ds_read_b64_tr_b16 v[234:235], v13 offset:9344
    v_cmp_lt_f32 vcc, 8.0, v18
    s_waitcnt lgkmcnt(8)
    v_readfirstlane_b32 s9, v22
    s_cbranch_vccnz L_c_slow0
    v_mfma_f32_32x32x16_bf16 v[144:159], v[240:243], v[24:27], v[144:159]
    ds_read_b64_tr_b16 v[236:237], v14 offset:6272
    ds_read_b64_tr_b16 v[238:239], v15 offset:9344
    v_exp_f32 v192, v192
    s_waitcnt lgkmcnt(8)
    v_mfma_f32_32x32x16_bf16 v[160:175], v[244:247], v[24:27], v[160:175]
    v_mfma_f32_16x16x32_bf16 v[248:251], v[252:255], v[24:27], v[248:251]
    ds_read_b64_tr_b16 v[240:241], v12 offset:6400
    ds_read_b64_tr_b16 v[242:243], v13 offset:9472
    v_exp_f32 v193, v193
    s_waitcnt lgkmcnt(6)
    v_mfma_f32_32x32x16_bf16 v[80:95], v[224:227], v[28:31], v[80:95]
    ds_read_b64_tr_b16 v[244:245], v14 offset:6400
    ds_read_b64_tr_b16 v[246:247], v15 offset:9472
    s_add_u32 s8, s14, 1
    s_cmp_ge_u32 s8, s10
    s_cbranch_scc1 L_c_rdy0
    s_cmp_ge_u32 s9, 4
    s_cbranch_scc0 L_c_nrdy0
L_c_rdy0:

    v_exp_f32 v194, v194
    v_mfma_f32_32x32x16_bf16 v[96:111], v[228:231], v[28:31], v[96:111]
    ds_read_b128 v[224:227], v8 offset:0
    v_exp_f32 v195, v195
    s_waitcnt lgkmcnt(5)
    v_mfma_f32_32x32x16_bf16 v[112:127], v[232:235], v[28:31], v[112:127]
    ds_read_b128 v[228:231], v9 offset:0
    v_exp_f32 v196, v196
    v_mfma_f32_32x32x16_bf16 v[128:143], v[236:239], v[28:31], v[128:143]
    ds_read_b128 v[232:235], v10 offset:0
    v_exp_f32 v197, v197
    s_waitcnt lgkmcnt(3)
    v_mfma_f32_32x32x16_bf16 v[144:159], v[240:243], v[28:31], v[144:159]
    ds_read_b128 v[236:239], v11 offset:0
    v_exp_f32 v198, v198
    v_mfma_f32_32x32x16_bf16 v[160:175], v[244:247], v[28:31], v[160:175]
    ds_read_b128 v[240:243], v8 offset:128
    v_exp_f32 v199, v199
    v_mfma_f32_16x16x32_bf16 v[248:251], v[252:255], v[28:31], v[248:251]
    v_add_u32 v12, 24576, v12
    v_add_u32 v13, 24576, v13
    v_add_u32 v14, 24576, v14
    v_add_u32 v15, 24576, v15
    v_add_u32 v21, 4, v21
L_c_it1:
    s_add_u32 s14, s14, 1
    s_cmp_lt_u32 s14, s10
    s_cbranch_scc0 L_c_last1

    s_cmp_lt_u32 s4, 2
    s_cbranch_scc1 L_c_nsw
    s_waitcnt vmcnt(0)
    v_mov_b32 v20, 159764
    v_mov_b32 v19, 1
    s_mov_b64 exec, 1
    ds_add_u32 v20, v19
    s_mov_b64 exec, -1
L_c_nsw:

    s_waitcnt lgkmcnt(3)
    v_mfma_f32_32x32x16_bf16 v[176:191], v[224:227], v[32:35], v[208:223]
    ds_read_b128 v[244:247], v9 offset:128
    v_exp_f32 v200, v200
    v_exp_f32 v201, v201
    v_mfma_f32_32x32x16_bf16 v[176:191], v[228:231], v[36:39], v[176:191]
    ds_read_b128 v[224:227], v10 offset:128
    v_exp_f32 v202, v202
    v_exp_f32 v203, v203
    s_waitcnt lgkmcnt(3)
    v_mfma_f32_32x32x16_bf16 v[176:191], v[232:235], v[40:43], v[176:191]
    ds_read_b128 v[228:231], v11 offset:128
    v_exp_f32 v204, v204
    v_exp_f32 v205, v205
    v_mfma_f32_32x32x16_bf16 v[176:191], v[236:239], v[44:47], v[176:191]
    ds_read_b128 v[232:235], v8 offset:256
    v_exp_f32 v206, v206
    v_exp_f32 v207, v207
    s_waitcnt lgkmcnt(3)
    v_mfma_f32_32x32x16_bf16 v[176:191], v[240:243], v[48:51], v[176:191]
    ds_read_b128 v[236:239], v9 offset:256
    v_cvt_pk_bf16_f32 v24, v192, v193
    v_cvt_pk_bf16_f32 v25, v194, v195
    v_mfma_f32_32x32x16_bf16 v[176:191], v[244:247], v[52:55], v[176:191]
    ds_read_b128 v[240:243], v10 offset:256
    v_cvt_pk_bf16_f32 v26, v196, v197
    v_cvt_pk_bf16_f32 v27, v198, v199
    s_waitcnt lgkmcnt(3)
    v_mfma_f32_32x32x16_bf16 v[176:191], v[224:227], v[56:59], v[176:191]
    ds_read_b128 v[244:247], v11 offset:256
    v_cvt_pk_bf16_f32 v28, v200, v201
    v_cvt_pk_bf16_f32 v29, v202, v203
    v_mfma_f32_32x32x16_bf16 v[176:191], v[228:231], v[60:63], v[176:191]
    ds_read_b64_tr_b16 v[224:225], v12 offset:0
    ds_read_b64_tr_b16 v[226:227], v13 offset:3072
    v_cvt_pk_bf16_f32 v30, v204, v205
    v_cvt_pk_bf16_f32 v31, v206, v207
    v_add_u32 v8, 24576, v8
    v_add_u32 v9, 24576, v9
    v_add_u32 v10, 24576, v10
    v_add_u32 v11, 24576, v11
    s_waitcnt lgkmcnt(4)
    v_mfma_f32_32x32x16_bf16 v[176:191], v[232:235], v[64:67], v[176:191]
    ds_read_b64_tr_b16 v[228:229], v14 offset:0
    ds_read_b64_tr_b16 v[230:231], v15 offset:3072
    v_mfma_f32_32x32x16_bf16 v[176:191], v[236:239], v[68:71], v[176:191]
    ds_read_b64_tr_b16 v[232:233], v12 offset:128
    ds_read_b64_tr_b16 v[234:235], v13 offset:3200
    s_waitcnt lgkmcnt(6)
    v_mfma_f32_32x32x16_bf16 v[176:191], v[240:243], v[72:75], v[176:191]
    ds_read_b64_tr_b16 v[236:237], v14 offset:128
    ds_read_b64_tr_b16 v[238:239], v15 offset:3200
    v_mfma_f32_32x32x16_bf16 v[176:191], v[244:247], v[76:79], v[176:191]
    ds_read_b64_tr_b16 v[240:241], v12 offset:256
    ds_read_b64_tr_b16 v[242:243], v13 offset:3328
    ds_read_b32 v22, v21
    s_waitcnt lgkmcnt(7)
    v_mfma_f32_32x32x16_bf16 v[80:95], v[224:227], v[24:27], v[80:95]
    ds_read_b64_tr_b16 v[244:245], v14 offset:256
    ds_read_b64_tr_b16 v[246:247], v15 offset:3328
    s_nop 4
    v_max3_f32 v18, v176, v177, v178
    v_max3_f32 v18, v18, v179, v180
    v_max3_f32 v18, v18, v181, v182
    v_mfma_f32_32x32x16_bf16 v[96:111], v[228:231], v[24:27], v[96:111]
    ds_read_b64_tr_b16 v[224:225], v12 offset:6144
    ds_read_b64_tr_b16 v[226:227], v13 offset:9216
    v_max3_f32 v18, v18, v183, v184
    v_max3_f32 v18, v18, v185, v186
    v_max3_f32 v18, v18, v187, v188
    s_waitcnt lgkmcnt(7)
    v_mfma_f32_32x32x16_bf16 v[112:127], v[232:235], v[24:27], v[112:127]
    ds_read_b64_tr_b16 v[228:229], v14 offset:6144
    ds_read_b64_tr_b16 v[230:231], v15 offset:9216
    v_max3_f32 v18, v18, v189, v190
    v_max_f32 v18, v18, v191
    v_mfma_f32_32x32x16_bf16 v[128:143], v[236:239], v[24:27], v[128:143]
    ds_read_b64_tr_b16 v[232:233], v12 offset:6272
    ds_read_b64_tr_b16 v[234:235], v13 offset:9344
    v_cmp_lt_f32 vcc, 8.0, v18
    s_waitcnt lgkmcnt(8)
    v_readfirstlane_b32 s9, v22
    s_cbranch_vccnz L_c_slow1
    v_mfma_f32_32x32x16_bf16 v[144:159], v[240:243], v[24:27], v[144:159]
    ds_read_b64_tr_b16 v[236:237], v14 offset:6272
    ds_read_b64_tr_b16 v[238:239], v15 offset:9344
    v_exp_f32 v176, v176
    s_waitcnt lgkmcnt(8)
    v_mfma_f32_32x32x16_bf16 v[160:175], v[244:247], v[24:27], v[160:175]
    v_mfma_f32_16x16x32_bf16 v[248:251], v[252:255], v[24:27], v[248:251]
    ds_read_b64_tr_b16 v[240:241], v12 offset:6400
    ds_read_b64_tr_b16 v[242:243], v13 offset:9472
    v_exp_f32 v177, v177
    s_waitcnt lgkmcnt(6)
    v_mfma_f32_32x32x16_bf16 v[80:95], v[224:227], v[28:31], v[80:95]
    ds_read_b64_tr_b16 v[244:245], v14 offset:6400
    ds_read_b64_tr_b16 v[246:247], v15 offset:9472
    s_add_u32 s8, s14, 1
    s_cmp_ge_u32 s8, s10
    s_cbranch_scc1 L_c_rdy1
    s_cmp_ge_u32 s9, 4
    s_cbranch_scc0 L_c_nrdy1
L_c_rdy1:

    v_exp_f32 v178, v178
    v_mfma_f32_32x32x16_bf16 v[96:111], v[228:231], v[28:31], v[96:111]
    ds_read_b128 v[224:227], v8 offset:0
    v_exp_f32 v179, v179
    s_waitcnt lgkmcnt(5)
    v_mfma_f32_32x32x16_bf16 v[112:127], v[232:235], v[28:31], v[112:127]
    ds_read_b128 v[228:231], v9 offset:0
    v_exp_f32 v180, v180
    v_mfma_f32_32x32x16_bf16 v[128:143], v[236:239], v[28:31], v[128:143]
    ds_read_b128 v[232:235], v10 offset:0
    v_exp_f32 v181, v181
    s_waitcnt lgkmcnt(3)
    v_mfma_f32_32x32x16_bf16 v[144:159], v[240:243], v[28:31], v[144:159]
    ds_read_b128 v[236:239], v11 offset:0
    v_exp_f32 v182, v182
    v_mfma_f32_32x32x16_bf16 v[160:175], v[244:247], v[28:31], v[160:175]
    ds_read_b128 v[240:243], v8 offset:128
    v_exp_f32 v183, v183
    v_mfma_f32_16x16x32_bf16 v[248:251], v[252:255], v[28:31], v[248:251]
    v_add_u32 v12, 24576, v12
    v_add_u32 v13, 24576, v13
    v_add_u32 v14, 24576, v14
    v_add_u32 v15, 24576, v15
    v_add_u32 v21, 4, v21
    s_branch L_c_it0
L_c_nrdy0:
    v_exp_f32 v194, v194
    v_mfma_f32_32x32x16_bf16 v[96:111], v[228:231], v[28:31], v[96:111]
    v_exp_f32 v195, v195
    s_waitcnt lgkmcnt(6)
    v_mfma_f32_32x32x16_bf16 v[112:127], v[232:235], v[28:31], v[112:127]
    v_exp_f32 v196, v196
    s_waitcnt lgkmcnt(4)
    v_mfma_f32_32x32x16_bf16 v[128:143], v[236:239], v[28:31], v[128:143]
    v_exp_f32 v197, v197
    s_waitcnt lgkmcnt(2)
    v_mfma_f32_32x32x16_bf16 v[144:159], v[240:243], v[28:31], v[144:159]
    v_exp_f32 v198, v198
    s_waitcnt lgkmcnt(0)
    v_mfma_f32_32x32x16_bf16 v[160:175], v[244:247], v[28:31], v[160:175]
    v_exp_f32 v199, v199
    v_mfma_f32_16x16x32_bf16 v[248:251], v[252:255], v[28:31], v[248:251]
    v_add_u32 v12, 24576, v12
    v_add_u32 v13, 24576, v13
    v_add_u32 v14, 24576, v14
    v_add_u32 v15, 24576, v15
L_c_nr0:
    ds_read_b32 v22, v21
    s_waitcnt lgkmcnt(0)
    v_readfirstlane_b32 s9, v22
    s_nop 0
    s_cmp_ge_u32 s9, 4
    s_cbranch_scc1 L_c_nr0_ok
    s_sleep 1
    s_add_u32 s13, s13, 1
    s_cmp_lt_u32 s13, 0x100000
    s_cbranch_scc1 L_c_nr0
L_c_nr0_ok:

    ds_read_b128 v[224:227], v8 offset:0
    ds_read_b128 v[228:231], v9 offset:0
    ds_read_b128 v[232:235], v10 offset:0
    ds_read_b128 v[236:239], v11 offset:0
    ds_read_b128 v[240:243], v8 offset:128
    v_add_u32 v21, 4, v21
    s_branch L_c_it1
L_c_nrdy1:
    v_exp_f32 v178, v178
    v_mfma_f32_32x32x16_bf16 v[96:111], v[228:231], v[28:31], v[96:111]
    v_exp_f32 v179, v179
    s_waitcnt lgkmcnt(6)
    v_mfma_f32_32x32x16_bf16 v[112:127], v[232:235], v[28:31], v[112:127]
    v_exp_f32 v180, v180
    s_waitcnt lgkmcnt(4)
    v_mfma_f32_32x32x16_bf16 v[128:143], v[236:239], v[28:31], v[128:143]
    v_exp_f32 v181, v181
    s_waitcnt lgkmcnt(2)
    v_mfma_f32_32x32x16_bf16 v[144:159], v[240:243], v[28:31], v[144:159]
    v_exp_f32 v182, v182
    s_waitcnt lgkmcnt(0)
    v_mfma_f32_32x32x16_bf16 v[160:175], v[244:247], v[28:31], v[160:175]
    v_exp_f32 v183, v183
    v_mfma_f32_16x16x32_bf16 v[248:251], v[252:255], v[28:31], v[248:251]
    v_add_u32 v12, 24576, v12
    v_add_u32 v13, 24576, v13
    v_add_u32 v14, 24576, v14
    v_add_u32 v15, 24576, v15
L_c_nr1:
    ds_read_b32 v22, v21
    s_waitcnt lgkmcnt(0)
    v_readfirstlane_b32 s9, v22
    s_nop 0
    s_cmp_ge_u32 s9, 4
    s_cbranch_scc1 L_c_nr1_ok
    s_sleep 1
    s_add_u32 s13, s13, 1
    s_cmp_lt_u32 s13, 0x100000
    s_cbranch_scc1 L_c_nr1
L_c_nr1_ok:

    ds_read_b128 v[224:227], v8 offset:0
    ds_read_b128 v[228:231], v9 offset:0
    ds_read_b128 v[232:235], v10 offset:0
    ds_read_b128 v[236:239], v11 offset:0
    ds_read_b128 v[240:243], v8 offset:128
    v_add_u32 v21, 4, v21
    s_branch L_c_it0
L_c_slow0:
    s_waitcnt lgkmcnt(0)
    v_mfma_f32_32x32x16_bf16 v[144:159], v[240:243], v[24:27], v[144:159]
    ds_read_b64_tr_b16 v[236:237], v14 offset:6272
    ds_read_b64_tr_b16 v[238:239], v15 offset:9344
    s_waitcnt lgkmcnt(0)
    v_mfma_f32_32x32x16_bf16 v[160:175], v[244:247], v[24:27], v[160:175]
    v_mfma_f32_16x16x32_bf16 v[248:251], v[252:255], v[24:27], v[248:251]
    ds_read_b64_tr_b16 v[240:241], v12 offset:6400
    ds_read_b64_tr_b16 v[242:243], v13 offset:9472
    s_waitcnt lgkmcnt(0)
    v_mfma_f32_32x32x16_bf16 v[80:95], v[224:227], v[28:31], v[80:95]
    ds_read_b64_tr_b16 v[244:245], v14 offset:6400
    ds_read_b64_tr_b16 v[246:247], v15 offset:9472
    s_waitcnt lgkmcnt(0)
    v_mfma_f32_32x32x16_bf16 v[96:111], v[228:231], v[28:31], v[96:111]
    s_waitcnt lgkmcnt(0)
    v_mfma_f32_32x32x16_bf16 v[112:127], v[232:235], v[28:31], v[112:127]
    s_waitcnt lgkmcnt(0)
    v_mfma_f32_32x32x16_bf16 v[128:143], v[236:239], v[28:31], v[128:143]
    s_waitcnt lgkmcnt(0)
    v_mfma_f32_32x32x16_bf16 v[144:159], v[240:243], v[28:31], v[144:159]
    s_waitcnt lgkmcnt(0)
    v_mfma_f32_32x32x16_bf16 v[160:175], v[244:247], v[28:31], v[160:175]
    v_mfma_f32_16x16x32_bf16 v[248:251], v[252:255], v[28:31], v[248:251]
    v_add_u32 v12, 24576, v12
    v_add_u32 v13, 24576, v13
    v_add_u32 v14, 24576, v14
    v_add_u32 v15, 24576, v15
    v_mov_b32 v19, v18
    s_nop 1
    v_permlane32_swap_b32 v19, v18
    v_max_f32 v18, v18, v19

    v_max_f32 v18, 0, v18
    v_sub_f32 v19, 0, v18
    v_exp_f32 v19, v19
    s_nop 0
    v_mov_b32 v20, v19
    v_mov_b32 v22, v19
    s_nop 1
    v_permlane16_swap_b32 v20, v22
    v_mul_f32 v248, v248, v20
    v_mul_f32 v249, v249, v22

    v_mul_f32 v80, v80, v19
    v_mul_f32 v81, v81, v19
    v_mul_f32 v82, v82, v19
    v_mul_f32 v83, v83, v19
    v_mul_f32 v84, v84, v19
    v_mul_f32 v85, v85, v19
    v_mul_f32 v86, v86, v19
    v_mul_f32 v87, v87, v19
    v_mul_f32 v88, v88, v19
    v_mul_f32 v89, v89, v19
    v_mul_f32 v90, v90, v19
    v_mul_f32 v91, v91, v19
    v_mul_f32 v92, v92, v19
    v_mul_f32 v93, v93, v19
    v_mul_f32 v94, v94, v19
    v_mul_f32 v95, v95, v19
    v_mul_f32 v96, v96, v19
    v_mul_f32 v97, v97, v19
    v_mul_f32 v98, v98, v19
    v_mul_f32 v99, v99, v19
    v_mul_f32 v100, v100, v19
    v_mul_f32 v101, v101, v19
    v_mul_f32 v102, v102, v19
    v_mul_f32 v103, v103, v19
    v_mul_f32 v104, v104, v19
    v_mul_f32 v105, v105, v19
    v_mul_f32 v106, v106, v19
    v_mul_f32 v107, v107, v19
    v_mul_f32 v108, v108, v19
    v_mul_f32 v109, v109, v19
    v_mul_f32 v110, v110, v19
    v_mul_f32 v111, v111, v19
    v_mul_f32 v112, v112, v19
    v_mul_f32 v113, v113, v19
    v_mul_f32 v114, v114, v19
    v_mul_f32 v115, v115, v19
    v_mul_f32 v116, v116, v19
    v_mul_f32 v117, v117, v19
    v_mul_f32 v118, v118, v19
    v_mul_f32 v119, v119, v19
    v_mul_f32 v120, v120, v19
    v_mul_f32 v121, v121, v19
    v_mul_f32 v122, v122, v19
    v_mul_f32 v123, v123, v19
    v_mul_f32 v124, v124, v19
    v_mul_f32 v125, v125, v19
    v_mul_f32 v126, v126, v19
    v_mul_f32 v127, v127, v19
    v_mul_f32 v128, v128, v19
    v_mul_f32 v129, v129, v19
    v_mul_f32 v130, v130, v19
    v_mul_f32 v131, v131, v19
    v_mul_f32 v132, v132, v19
    v_mul_f32 v133, v133, v19
    v_mul_f32 v134, v134, v19
    v_mul_f32 v135, v135, v19
    v_mul_f32 v136, v136, v19
    v_mul_f32 v137, v137, v19
    v_mul_f32 v138, v138, v19
    v_mul_f32 v139, v139, v19
    v_mul_f32 v140, v140, v19
    v_mul_f32 v141, v141, v19
    v_mul_f32 v142, v142, v19
    v_mul_f32 v143, v143, v19
    v_mul_f32 v144, v144, v19
    v_mul_f32 v145, v145, v19
    v_mul_f32 v146, v146, v19
    v_mul_f32 v147, v147, v19
    v_mul_f32 v148, v148, v19
    v_mul_f32 v149, v149, v19
    v_mul_f32 v150, v150, v19
    v_mul_f32 v151, v151, v19
    v_mul_f32 v152, v152, v19
    v_mul_f32 v153, v153, v19
    v_mul_f32 v154, v154, v19
    v_mul_f32 v155, v155, v19
    v_mul_f32 v156, v156, v19
    v_mul_f32 v157, v157, v19
    v_mul_f32 v158, v158, v19
    v_mul_f32 v159, v159, v19
    v_mul_f32 v160, v160, v19
    v_mul_f32 v161, v161, v19
    v_mul_f32 v162, v162, v19
    v_mul_f32 v163, v163, v19
    v_mul_f32 v164, v164, v19
    v_mul_f32 v165, v165, v19
    v_mul_f32 v166, v166, v19
    v_mul_f32 v167, v167, v19
    v_mul_f32 v168, v168, v19
    v_mul_f32 v169, v169, v19
    v_mul_f32 v170, v170, v19
    v_mul_f32 v171, v171, v19
    v_mul_f32 v172, v172, v19
    v_mul_f32 v173, v173, v19
    v_mul_f32 v174, v174, v19
    v_mul_f32 v175, v175, v19
    v_add_f32 v17, v17, v18
    v_sub_f32 v192, v192, v18
    v_sub_f32 v193, v193, v18
    v_sub_f32 v194, v194, v18
    v_sub_f32 v195, v195, v18
    v_sub_f32 v196, v196, v18
    v_sub_f32 v197, v197, v18
    v_sub_f32 v198, v198, v18
    v_sub_f32 v199, v199, v18
    v_sub_f32 v200, v200, v18
    v_sub_f32 v201, v201, v18
    v_sub_f32 v202, v202, v18
    v_sub_f32 v203, v203, v18
    v_sub_f32 v204, v204, v18
    v_sub_f32 v205, v205, v18
    v_sub_f32 v206, v206, v18
    v_sub_f32 v207, v207, v18
    v_sub_f32 v208, v208, v18
    v_sub_f32 v209, v209, v18
    v_sub_f32 v210, v210, v18
    v_sub_f32 v211, v211, v18
    v_sub_f32 v212, v212, v18
    v_sub_f32 v213, v213, v18
    v_sub_f32 v214, v214, v18
    v_sub_f32 v215, v215, v18
    v_sub_f32 v216, v216, v18
    v_sub_f32 v217, v217, v18
    v_sub_f32 v218, v218, v18
    v_sub_f32 v219, v219, v18
    v_sub_f32 v220, v220, v18
    v_sub_f32 v221, v221, v18
    v_sub_f32 v222, v222, v18
    v_sub_f32 v223, v223, v18
    v_exp_f32 v192, v192
    v_exp_f32 v193, v193
    v_exp_f32 v194, v194
    v_exp_f32 v195, v195
    v_exp_f32 v196, v196
    v_exp_f32 v197, v197
    v_exp_f32 v198, v198
    v_exp_f32 v199, v199
    s_add_u32 s8, s14, 1
    s_cmp_ge_u32 s8, s10
    s_cbranch_scc1 L_c_sl0_go
L_c_sl0:
    ds_read_b32 v22, v21
    s_waitcnt lgkmcnt(0)
    v_readfirstlane_b32 s9, v22
    s_nop 0
    s_cmp_ge_u32 s9, 4
    s_cbranch_scc1 L_c_sl0_ok
    s_sleep 1
    s_add_u32 s13, s13, 1
    s_cmp_lt_u32 s13, 0x100000
    s_cbranch_scc1 L_c_sl0
L_c_sl0_ok:

L_c_sl0_go:
    ds_read_b128 v[224:227], v8 offset:0
    ds_read_b128 v[228:231], v9 offset:0
    ds_read_b128 v[232:235], v10 offset:0
    ds_read_b128 v[236:239], v11 offset:0
    ds_read_b128 v[240:243], v8 offset:128
    v_add_u32 v21, 4, v21
    s_branch L_c_it1
L_c_slow1:
    s_waitcnt lgkmcnt(0)
    v_mfma_f32_32x32x16_bf16 v[144:159], v[240:243], v[24:27], v[144:159]
    ds_read_b64_tr_b16 v[236:237], v14 offset:6272
    ds_read_b64_tr_b16 v[238:239], v15 offset:9344
    s_waitcnt lgkmcnt(0)
    v_mfma_f32_32x32x16_bf16 v[160:175], v[244:247], v[24:27], v[160:175]
    v_mfma_f32_16x16x32_bf16 v[248:251], v[252:255], v[24:27], v[248:251]
    ds_read_b64_tr_b16 v[240:241], v12 offset:6400
    ds_read_b64_tr_b16 v[242:243], v13 offset:9472
    s_waitcnt lgkmcnt(0)
    v_mfma_f32_32x32x16_bf16 v[80:95], v[224:227], v[28:31], v[80:95]
    ds_read_b64_tr_b16 v[244:245], v14 offset:6400
    ds_read_b64_tr_b16 v[246:247], v15 offset:9472
    s_waitcnt lgkmcnt(0)
    v_mfma_f32_32x32x16_bf16 v[96:111], v[228:231], v[28:31], v[96:111]
    s_waitcnt lgkmcnt(0)
    v_mfma_f32_32x32x16_bf16 v[112:127], v[232:235], v[28:31], v[112:127]
    s_waitcnt lgkmcnt(0)
    v_mfma_f32_32x32x16_bf16 v[128:143], v[236:239], v[28:31], v[128:143]
    s_waitcnt lgkmcnt(0)
    v_mfma_f32_32x32x16_bf16 v[144:159], v[240:243], v[28:31], v[144:159]
    s_waitcnt lgkmcnt(0)
    v_mfma_f32_32x32x16_bf16 v[160:175], v[244:247], v[28:31], v[160:175]
    v_mfma_f32_16x16x32_bf16 v[248:251], v[252:255], v[28:31], v[248:251]
    v_add_u32 v12, 24576, v12
    v_add_u32 v13, 24576, v13
    v_add_u32 v14, 24576, v14
    v_add_u32 v15, 24576, v15
    v_mov_b32 v19, v18
    s_nop 1
    v_permlane32_swap_b32 v19, v18
    v_max_f32 v18, v18, v19

    v_max_f32 v18, 0, v18
    v_sub_f32 v19, 0, v18
    v_exp_f32 v19, v19
    s_nop 0
    v_mov_b32 v20, v19
    v_mov_b32 v22, v19
    s_nop 1
    v_permlane16_swap_b32 v20, v22
    v_mul_f32 v248, v248, v20
    v_mul_f32 v249, v249, v22

    v_mul_f32 v80, v80, v19
    v_mul_f32 v81, v81, v19
    v_mul_f32 v82, v82, v19
    v_mul_f32 v83, v83, v19
    v_mul_f32 v84, v84, v19
    v_mul_f32 v85, v85, v19
    v_mul_f32 v86, v86, v19
    v_mul_f32 v87, v87, v19
    v_mul_f32 v88, v88, v19
    v_mul_f32 v89, v89, v19
    v_mul_f32 v90, v90, v19
    v_mul_f32 v91, v91, v19
    v_mul_f32 v92, v92, v19
    v_mul_f32 v93, v93, v19
    v_mul_f32 v94, v94, v19
    v_mul_f32 v95, v95, v19
    v_mul_f32 v96, v96, v19
    v_mul_f32 v97, v97, v19
    v_mul_f32 v98, v98, v19
    v_mul_f32 v99, v99, v19
    v_mul_f32 v100, v100, v19
    v_mul_f32 v101, v101, v19
    v_mul_f32 v102, v102, v19
    v_mul_f32 v103, v103, v19
    v_mul_f32 v104, v104, v19
    v_mul_f32 v105, v105, v19
    v_mul_f32 v106, v106, v19
    v_mul_f32 v107, v107, v19
    v_mul_f32 v108, v108, v19
    v_mul_f32 v109, v109, v19
    v_mul_f32 v110, v110, v19
    v_mul_f32 v111, v111, v19
    v_mul_f32 v112, v112, v19
    v_mul_f32 v113, v113, v19
    v_mul_f32 v114, v114, v19
    v_mul_f32 v115, v115, v19
    v_mul_f32 v116, v116, v19
    v_mul_f32 v117, v117, v19
    v_mul_f32 v118, v118, v19
    v_mul_f32 v119, v119, v19
    v_mul_f32 v120, v120, v19
    v_mul_f32 v121, v121, v19
    v_mul_f32 v122, v122, v19
    v_mul_f32 v123, v123, v19
    v_mul_f32 v124, v124, v19
    v_mul_f32 v125, v125, v19
    v_mul_f32 v126, v126, v19
    v_mul_f32 v127, v127, v19
    v_mul_f32 v128, v128, v19
    v_mul_f32 v129, v129, v19
    v_mul_f32 v130, v130, v19
    v_mul_f32 v131, v131, v19
    v_mul_f32 v132, v132, v19
    v_mul_f32 v133, v133, v19
    v_mul_f32 v134, v134, v19
    v_mul_f32 v135, v135, v19
    v_mul_f32 v136, v136, v19
    v_mul_f32 v137, v137, v19
    v_mul_f32 v138, v138, v19
    v_mul_f32 v139, v139, v19
    v_mul_f32 v140, v140, v19
    v_mul_f32 v141, v141, v19
    v_mul_f32 v142, v142, v19
    v_mul_f32 v143, v143, v19
    v_mul_f32 v144, v144, v19
    v_mul_f32 v145, v145, v19
    v_mul_f32 v146, v146, v19
    v_mul_f32 v147, v147, v19
    v_mul_f32 v148, v148, v19
    v_mul_f32 v149, v149, v19
    v_mul_f32 v150, v150, v19
    v_mul_f32 v151, v151, v19
    v_mul_f32 v152, v152, v19
    v_mul_f32 v153, v153, v19
    v_mul_f32 v154, v154, v19
    v_mul_f32 v155, v155, v19
    v_mul_f32 v156, v156, v19
    v_mul_f32 v157, v157, v19
    v_mul_f32 v158, v158, v19
    v_mul_f32 v159, v159, v19
    v_mul_f32 v160, v160, v19
    v_mul_f32 v161, v161, v19
    v_mul_f32 v162, v162, v19
    v_mul_f32 v163, v163, v19
    v_mul_f32 v164, v164, v19
    v_mul_f32 v165, v165, v19
    v_mul_f32 v166, v166, v19
    v_mul_f32 v167, v167, v19
    v_mul_f32 v168, v168, v19
    v_mul_f32 v169, v169, v19
    v_mul_f32 v170, v170, v19
    v_mul_f32 v171, v171, v19
    v_mul_f32 v172, v172, v19
    v_mul_f32 v173, v173, v19
    v_mul_f32 v174, v174, v19
    v_mul_f32 v175, v175, v19
    v_add_f32 v17, v17, v18
    v_sub_f32 v176, v176, v18
    v_sub_f32 v177, v177, v18
    v_sub_f32 v178, v178, v18
    v_sub_f32 v179, v179, v18
    v_sub_f32 v180, v180, v18
    v_sub_f32 v181, v181, v18
    v_sub_f32 v182, v182, v18
    v_sub_f32 v183, v183, v18
    v_sub_f32 v184, v184, v18
    v_sub_f32 v185, v185, v18
    v_sub_f32 v186, v186, v18
    v_sub_f32 v187, v187, v18
    v_sub_f32 v188, v188, v18
    v_sub_f32 v189, v189, v18
    v_sub_f32 v190, v190, v18
    v_sub_f32 v191, v191, v18
    v_sub_f32 v208, v208, v18
    v_sub_f32 v209, v209, v18
    v_sub_f32 v210, v210, v18
    v_sub_f32 v211, v211, v18
    v_sub_f32 v212, v212, v18
    v_sub_f32 v213, v213, v18
    v_sub_f32 v214, v214, v18
    v_sub_f32 v215, v215, v18
    v_sub_f32 v216, v216, v18
    v_sub_f32 v217, v217, v18
    v_sub_f32 v218, v218, v18
    v_sub_f32 v219, v219, v18
    v_sub_f32 v220, v220, v18
    v_sub_f32 v221, v221, v18
    v_sub_f32 v222, v222, v18
    v_sub_f32 v223, v223, v18
    v_exp_f32 v176, v176
    v_exp_f32 v177, v177
    v_exp_f32 v178, v178
    v_exp_f32 v179, v179
    v_exp_f32 v180, v180
    v_exp_f32 v181, v181
    v_exp_f32 v182, v182
    v_exp_f32 v183, v183
    s_add_u32 s8, s14, 1
    s_cmp_ge_u32 s8, s10
    s_cbranch_scc1 L_c_sl1_go
L_c_sl1:
    ds_read_b32 v22, v21
    s_waitcnt lgkmcnt(0)
    v_readfirstlane_b32 s9, v22
    s_nop 0
    s_cmp_ge_u32 s9, 4
    s_cbranch_scc1 L_c_sl1_ok
    s_sleep 1
    s_add_u32 s13, s13, 1
    s_cmp_lt_u32 s13, 0x100000
    s_cbranch_scc1 L_c_sl1
L_c_sl1_ok:

L_c_sl1_go:
    ds_read_b128 v[224:227], v8 offset:0
    ds_read_b128 v[228:231], v9 offset:0
    ds_read_b128 v[232:235], v10 offset:0
    ds_read_b128 v[236:239], v11 offset:0
    ds_read_b128 v[240:243], v8 offset:128
    v_add_u32 v21, 4, v21
    s_branch L_c_it0
L_c_last0:
    ds_read_b64_tr_b16 v[224:225], v12 offset:0
    ds_read_b64_tr_b16 v[226:227], v13 offset:3072
    ds_read_b64_tr_b16 v[228:229], v14 offset:0
    ds_read_b64_tr_b16 v[230:231], v15 offset:3072
    ds_read_b64_tr_b16 v[232:233], v12 offset:128
    ds_read_b64_tr_b16 v[234:235], v13 offset:3200
    ds_read_b64_tr_b16 v[236:237], v14 offset:128
    ds_read_b64_tr_b16 v[238:239], v15 offset:3200
    ds_read_b64_tr_b16 v[240:241], v12 offset:256
    ds_read_b64_tr_b16 v[242:243], v13 offset:3328
    v_mov_b32 v21, 159764
    ds_read_b32 v22, v21
    v_exp_f32 v184, v184
    v_exp_f32 v185, v185
    v_exp_f32 v186, v186
    v_exp_f32 v187, v187
    v_exp_f32 v188, v188
    v_exp_f32 v189, v189
    v_exp_f32 v190, v190
    v_exp_f32 v191, v191
    v_cvt_pk_bf16_f32 v24, v176, v177
    v_cvt_pk_bf16_f32 v25, v178, v179
    v_cvt_pk_bf16_f32 v26, v180, v181
    v_cvt_pk_bf16_f32 v27, v182, v183
    v_cvt_pk_bf16_f32 v28, v184, v185
    v_cvt_pk_bf16_f32 v29, v186, v187
    v_cvt_pk_bf16_f32 v30, v188, v189
    v_cvt_pk_bf16_f32 v31, v190, v191
    s_waitcnt lgkmcnt(9)
    v_mfma_f32_32x32x16_bf16 v[80:95], v[224:227], v[24:27], v[80:95]
    ds_read_b64_tr_b16 v[244:245], v14 offset:256
    ds_read_b64_tr_b16 v[246:247], v15 offset:3328
    s_waitcnt lgkmcnt(9)
    v_mfma_f32_32x32x16_bf16 v[96:111], v[228:231], v[24:27], v[96:111]
    ds_read_b64_tr_b16 v[224:225], v12 offset:6144
    ds_read_b64_tr_b16 v[226:227], v13 offset:9216
    s_waitcnt lgkmcnt(9)
    v_mfma_f32_32x32x16_bf16 v[112:127], v[232:235], v[24:27], v[112:127]
    ds_read_b64_tr_b16 v[228:229], v14 offset:6144
    ds_read_b64_tr_b16 v[230:231], v15 offset:9216
    s_waitcnt lgkmcnt(6)
    v_readfirstlane_b32 s9, v22
    s_nop 0
    s_cmp_ge_u32 s9, 6
    s_cbranch_scc1 L_c_lw0_ok
    s_waitcnt lgkmcnt(0)
L_c_lw0:
    ds_read_b32 v22, v21
    s_waitcnt lgkmcnt(0)
    v_readfirstlane_b32 s9, v22
    s_nop 0
    s_cmp_ge_u32 s9, 6
    s_cbranch_scc1 L_c_lw0_ok
    s_sleep 1
    s_add_u32 s13, s13, 1
    s_cmp_lt_u32 s13, 0x100000
    s_cbranch_scc1 L_c_lw0
L_c_lw0_ok:

L_c_lw0_ok2:
    v_mfma_f32_32x32x16_bf16 v[128:143], v[236:239], v[24:27], v[128:143]
    ds_read_b64_tr_b16 v[232:233], v12 offset:6272
    ds_read_b64_tr_b16 v[234:235], v13 offset:9344
    v_mfma_f32_32x32x16_bf16 v[144:159], v[240:243], v[24:27], v[144:159]
    ds_read_b64_tr_b16 v[236:237], v14 offset:6272
    ds_read_b64_tr_b16 v[238:239], v15 offset:9344
    s_waitcnt lgkmcnt(8)
    v_mfma_f32_32x32x16_bf16 v[160:175], v[244:247], v[24:27], v[160:175]
    v_mfma_f32_16x16x32_bf16 v[248:251], v[252:255], v[24:27], v[248:251]
    ds_read_b64_tr_b16 v[240:241], v12 offset:6400
    ds_read_b64_tr_b16 v[242:243], v13 offset:9472
    s_waitcnt lgkmcnt(8)
    v_mfma_f32_32x32x16_bf16 v[80:95], v[224:227], v[28:31], v[80:95]
    ds_read_b64_tr_b16 v[244:245], v14 offset:6400
    ds_read_b64_tr_b16 v[246:247], v15 offset:9472
    s_waitcnt lgkmcnt(8)
    v_mfma_f32_32x32x16_bf16 v[96:111], v[228:231], v[28:31], v[96:111]
    s_waitcnt lgkmcnt(6)
    v_mfma_f32_32x32x16_bf16 v[112:127], v[232:235], v[28:31], v[112:127]
    s_waitcnt lgkmcnt(4)
    v_mfma_f32_32x32x16_bf16 v[128:143], v[236:239], v[28:31], v[128:143]
    s_nop 3
    v_cvt_pk_bf16_f32 v176, v80, v81
    v_cvt_pk_bf16_f32 v177, v82, v83
    v_cvt_pk_bf16_f32 v180, v84, v85
    v_cvt_pk_bf16_f32 v181, v86, v87
    v_cvt_pk_bf16_f32 v178, v88, v89
    v_cvt_pk_bf16_f32 v179, v90, v91
    v_cvt_pk_bf16_f32 v182, v92, v93
    v_cvt_pk_bf16_f32 v183, v94, v95
    v_permlane16_swap_b32 v176, v180
    v_permlane16_swap_b32 v177, v181
    v_permlane16_swap_b32 v178, v182
    v_permlane16_swap_b32 v179, v183
    s_waitcnt lgkmcnt(2)
    v_mfma_f32_32x32x16_bf16 v[144:159], v[240:243], v[28:31], v[144:159]
    ds_read_b64_tr_b16 v[56:57], v2 offset:0
    ds_read_b64_tr_b16 v[58:59], v2 offset:1536
    ds_read_b64_tr_b16 v[60:61], v2 offset:8
    ds_read_b64_tr_b16 v[62:63], v2 offset:1544
    ds_read_b64_tr_b16 v[64:65], v2 offset:16
    ds_read_b64_tr_b16 v[66:67], v2 offset:1552
    ds_read_b64_tr_b16 v[68:69], v3 offset:0
    ds_read_b64_tr_b16 v[70:71], v3 offset:1536
    ds_read_b64_tr_b16 v[72:73], v3 offset:8
    ds_read_b64_tr_b16 v[74:75], v3 offset:1544
    ds_read_b64_tr_b16 v[76:77], v3 offset:16
    ds_read_b64_tr_b16 v[78:79], v3 offset:1552
    s_waitcnt lgkmcnt(12)
    v_mfma_f32_32x32x16_bf16 v[160:175], v[244:247], v[28:31], v[160:175]
    v_mfma_f32_16x16x32_bf16 v[248:251], v[252:255], v[28:31], v[248:251]
    s_branch L_c_done
L_c_last1:
    ds_read_b64_tr_b16 v[224:225], v12 offset:0
    ds_read_b64_tr_b16 v[226:227], v13 offset:3072
    ds_read_b64_tr_b16 v[228:229], v14 offset:0
    ds_read_b64_tr_b16 v[230:231], v15 offset:3072
    ds_read_b64_tr_b16 v[232:233], v12 offset:128
    ds_read_b64_tr_b16 v[234:235], v13 offset:3200
    ds_read_b64_tr_b16 v[236:237], v14 offset:128
    ds_read_b64_tr_b16 v[238:239], v15 offset:3200
    ds_read_b64_tr_b16 v[240:241], v12 offset:256
    ds_read_b64_tr_b16 v[242:243], v13 offset:3328
    v_mov_b32 v21, 159764
    ds_read_b32 v22, v21
    v_exp_f32 v200, v200
    v_exp_f32 v201, v201
    v_exp_f32 v202, v202
    v_exp_f32 v203, v203
    v_exp_f32 v204, v204
    v_exp_f32 v205, v205
    v_exp_f32 v206, v206
    v_exp_f32 v207, v207
    v_cvt_pk_bf16_f32 v24, v192, v193
    v_cvt_pk_bf16_f32 v25, v194, v195
    v_cvt_pk_bf16_f32 v26, v196, v197
    v_cvt_pk_bf16_f32 v27, v198, v199
    v_cvt_pk_bf16_f32 v28, v200, v201
    v_cvt_pk_bf16_f32 v29, v202, v203
    v_cvt_pk_bf16_f32 v30, v204, v205
    v_cvt_pk_bf16_f32 v31, v206, v207
    s_waitcnt lgkmcnt(9)
    v_mfma_f32_32x32x16_bf16 v[80:95], v[224:227], v[24:27], v[80:95]
    ds_read_b64_tr_b16 v[244:245], v14 offset:256
    ds_read_b64_tr_b16 v[246:247], v15 offset:3328
    s_waitcnt lgkmcnt(9)
    v_mfma_f32_32x32x16_bf16 v[96:111], v[228:231], v[24:27], v[96:111]
    ds_read_b64_tr_b16 v[224:225], v12 offset:6144
    ds_read_b64_tr_b16 v[226:227], v13 offset:9216
    s_waitcnt lgkmcnt(9)
    v_mfma_f32_32x32x16_bf16 v[112:127], v[232:235], v[24:27], v[112:127]
    ds_read_b64_tr_b16 v[228:229], v14 offset:6144
    ds_read_b64_tr_b16 v[230:231], v15 offset:9216
    s_waitcnt lgkmcnt(6)
    v_readfirstlane_b32 s9, v22
    s_nop 0
    s_cmp_ge_u32 s9, 6
    s_cbranch_scc1 L_c_lw1_ok
    s_waitcnt lgkmcnt(0)
L_c_lw1:
    ds_read_b32 v22, v21
    s_waitcnt lgkmcnt(0)
    v_readfirstlane_b32 s9, v22
    s_nop 0
    s_cmp_ge_u32 s9, 6
    s_cbranch_scc1 L_c_lw1_ok
    s_sleep 1
    s_add_u32 s13, s13, 1
    s_cmp_lt_u32 s13, 0x100000
    s_cbranch_scc1 L_c_lw1
L_c_lw1_ok:

L_c_lw1_ok2:
    v_mfma_f32_32x32x16_bf16 v[128:143], v[236:239], v[24:27], v[128:143]
    ds_read_b64_tr_b16 v[232:233], v12 offset:6272
    ds_read_b64_tr_b16 v[234:235], v13 offset:9344
    v_mfma_f32_32x32x16_bf16 v[144:159], v[240:243], v[24:27], v[144:159]
    ds_read_b64_tr_b16 v[236:237], v14 offset:6272
    ds_read_b64_tr_b16 v[238:239], v15 offset:9344
    s_waitcnt lgkmcnt(8)
    v_mfma_f32_32x32x16_bf16 v[160:175], v[244:247], v[24:27], v[160:175]
    v_mfma_f32_16x16x32_bf16 v[248:251], v[252:255], v[24:27], v[248:251]
    ds_read_b64_tr_b16 v[240:241], v12 offset:6400
    ds_read_b64_tr_b16 v[242:243], v13 offset:9472
    s_waitcnt lgkmcnt(8)
    v_mfma_f32_32x32x16_bf16 v[80:95], v[224:227], v[28:31], v[80:95]
    ds_read_b64_tr_b16 v[244:245], v14 offset:6400
    ds_read_b64_tr_b16 v[246:247], v15 offset:9472
    s_waitcnt lgkmcnt(8)
    v_mfma_f32_32x32x16_bf16 v[96:111], v[228:231], v[28:31], v[96:111]
    s_waitcnt lgkmcnt(6)
    v_mfma_f32_32x32x16_bf16 v[112:127], v[232:235], v[28:31], v[112:127]
    s_waitcnt lgkmcnt(4)
    v_mfma_f32_32x32x16_bf16 v[128:143], v[236:239], v[28:31], v[128:143]
    s_nop 3
    v_cvt_pk_bf16_f32 v176, v80, v81
    v_cvt_pk_bf16_f32 v177, v82, v83
    v_cvt_pk_bf16_f32 v180, v84, v85
    v_cvt_pk_bf16_f32 v181, v86, v87
    v_cvt_pk_bf16_f32 v178, v88, v89
    v_cvt_pk_bf16_f32 v179, v90, v91
    v_cvt_pk_bf16_f32 v182, v92, v93
    v_cvt_pk_bf16_f32 v183, v94, v95
    v_permlane16_swap_b32 v176, v180
    v_permlane16_swap_b32 v177, v181
    v_permlane16_swap_b32 v178, v182
    v_permlane16_swap_b32 v179, v183
    s_waitcnt lgkmcnt(2)
    v_mfma_f32_32x32x16_bf16 v[144:159], v[240:243], v[28:31], v[144:159]
    ds_read_b64_tr_b16 v[56:57], v2 offset:0
    ds_read_b64_tr_b16 v[58:59], v2 offset:1536
    ds_read_b64_tr_b16 v[60:61], v2 offset:8
    ds_read_b64_tr_b16 v[62:63], v2 offset:1544
    ds_read_b64_tr_b16 v[64:65], v2 offset:16
    ds_read_b64_tr_b16 v[66:67], v2 offset:1552
    ds_read_b64_tr_b16 v[68:69], v3 offset:0
    ds_read_b64_tr_b16 v[70:71], v3 offset:1536
    ds_read_b64_tr_b16 v[72:73], v3 offset:8
    ds_read_b64_tr_b16 v[74:75], v3 offset:1544
    ds_read_b64_tr_b16 v[76:77], v3 offset:16
    ds_read_b64_tr_b16 v[78:79], v3 offset:1552
    s_waitcnt lgkmcnt(12)
    v_mfma_f32_32x32x16_bf16 v[160:175], v[244:247], v[28:31], v[160:175]
    v_mfma_f32_16x16x32_bf16 v[248:251], v[252:255], v[28:31], v[248:251]
L_c_done:
    s_waitcnt lgkmcnt(0)
    v_mfma_f32_16x16x32_bf16 v[32:35], v[56:59], v[176:179], 0
    ds_read_b64_tr_b16 v[224:225], v2 offset:3072
    ds_read_b64_tr_b16 v[226:227], v2 offset:4608
    v_cvt_pk_bf16_f32 v184, v96, v97
    v_cvt_pk_bf16_f32 v185, v98, v99
    v_mfma_f32_16x16x32_bf16 v[36:39], v[60:63], v[176:179], 0
    ds_read_b64_tr_b16 v[228:229], v2 offset:3080
    ds_read_b64_tr_b16 v[230:231], v2 offset:4616
    v_cvt_pk_bf16_f32 v188, v100, v101
    v_cvt_pk_bf16_f32 v189, v102, v103
    v_mfma_f32_16x16x32_bf16 v[40:43], v[64:67], v[176:179], 0
    ds_read_b64_tr_b16 v[232:233], v2 offset:3088
    ds_read_b64_tr_b16 v[234:235], v2 offset:4624
    v_cvt_pk_bf16_f32 v186, v104, v105
    v_cvt_pk_bf16_f32 v187, v106, v107
    v_mfma_f32_16x16x32_bf16 v[44:47], v[68:71], v[180:183], 0
    ds_read_b64_tr_b16 v[236:237], v3 offset:3072
    ds_read_b64_tr_b16 v[238:239], v3 offset:4608
    v_cvt_pk_bf16_f32 v190, v108, v109
    v_cvt_pk_bf16_f32 v191, v110, v111
    v_mfma_f32_16x16x32_bf16 v[48:51], v[72:75], v[180:183], 0
    ds_read_b64_tr_b16 v[240:241], v3 offset:3080
    ds_read_b64_tr_b16 v[242:243], v3 offset:4616
    v_permlane16_swap_b32 v184, v188
    v_permlane16_swap_b32 v185, v189
    v_mfma_f32_16x16x32_bf16 v[52:55], v[76:79], v[180:183], 0
    ds_read_b64_tr_b16 v[244:245], v3 offset:3088
    ds_read_b64_tr_b16 v[246:247], v3 offset:4624
    v_permlane16_swap_b32 v186, v190
    v_permlane16_swap_b32 v187, v191
    s_waitcnt lgkmcnt(0)
    s_nop 0
    v_mfma_f32_16x16x32_bf16 v[32:35], v[224:227], v[184:187], v[32:35]
    ds_read_b64_tr_b16 v[56:57], v2 offset:6144
    ds_read_b64_tr_b16 v[58:59], v2 offset:7680
    v_cvt_pk_bf16_f32 v192, v112, v113
    v_cvt_pk_bf16_f32 v193, v114, v115
    v_mfma_f32_16x16x32_bf16 v[36:39], v[228:231], v[184:187], v[36:39]
    ds_read_b64_tr_b16 v[60:61], v2 offset:6152
    ds_read_b64_tr_b16 v[62:63], v2 offset:7688
    v_cvt_pk_bf16_f32 v196, v116, v117
    v_cvt_pk_bf16_f32 v197, v118, v119
    v_mfma_f32_16x16x32_bf16 v[40:43], v[232:235], v[184:187], v[40:43]
    ds_read_b64_tr_b16 v[64:65], v2 offset:6160
    ds_read_b64_tr_b16 v[66:67], v2 offset:7696
    v_cvt_pk_bf16_f32 v194, v120, v121
    v_cvt_pk_bf16_f32 v195, v122, v123
    v_mfma_f32_16x16x32_bf16 v[44:47], v[236:239], v[188:191], v[44:47]
    ds_read_b64_tr_b16 v[68:69], v3 offset:6144
    ds_read_b64_tr_b16 v[70:71], v3 offset:7680
    v_cvt_pk_bf16_f32 v198, v124, v125
    v_cvt_pk_bf16_f32 v199, v126, v127
    v_mfma_f32_16x16x32_bf16 v[48:51], v[240:243], v[188:191], v[48:51]
    ds_read_b64_tr_b16 v[72:73], v3 offset:6152
    ds_read_b64_tr_b16 v[74:75], v3 offset:7688
    v_permlane16_swap_b32 v192, v196
    v_permlane16_swap_b32 v193, v197
    v_mfma_f32_16x16x32_bf16 v[52:55], v[244:247], v[188:191], v[52:55]
    ds_read_b64_tr_b16 v[76:77], v3 offset:6160
    ds_read_b64_tr_b16 v[78:79], v3 offset:7696
    v_permlane16_swap_b32 v194, v198
    v_permlane16_swap_b32 v195, v199
    s_waitcnt lgkmcnt(0)
    s_nop 0
    v_mfma_f32_16x16x32_bf16 v[32:35], v[56:59], v[192:195], v[32:35]
    ds_read_b64_tr_b16 v[224:225], v2 offset:9216
    ds_read_b64_tr_b16 v[226:227], v2 offset:10752
    v_cvt_pk_bf16_f32 v200, v128, v129
    v_cvt_pk_bf16_f32 v201, v130, v131
    v_mfma_f32_16x16x32_bf16 v[36:39], v[60:63], v[192:195], v[36:39]
    ds_read_b64_tr_b16 v[228:229], v2 offset:9224
    ds_read_b64_tr_b16 v[230:231], v2 offset:10760
    v_cvt_pk_bf16_f32 v204, v132, v133
    v_cvt_pk_bf16_f32 v205, v134, v135
    v_mfma_f32_16x16x32_bf16 v[40:43], v[64:67], v[192:195], v[40:43]
    ds_read_b64_tr_b16 v[232:233], v2 offset:9232
    ds_read_b64_tr_b16 v[234:235], v2 offset:10768
    v_cvt_pk_bf16_f32 v202, v136, v137
    v_cvt_pk_bf16_f32 v203, v138, v139
    v_mfma_f32_16x16x32_bf16 v[44:47], v[68:71], v[196:199], v[44:47]
    ds_read_b64_tr_b16 v[236:237], v3 offset:9216
    ds_read_b64_tr_b16 v[238:239], v3 offset:10752
    v_cvt_pk_bf16_f32 v206, v140, v141
    v_cvt_pk_bf16_f32 v207, v142, v143
    v_mfma_f32_16x16x32_bf16 v[48:51], v[72:75], v[196:199], v[48:51]
    ds_read_b64_tr_b16 v[240:241], v3 offset:9224
    ds_read_b64_tr_b16 v[242:243], v3 offset:10760
    v_permlane16_swap_b32 v200, v204
    v_permlane16_swap_b32 v201, v205
    v_mfma_f32_16x16x32_bf16 v[52:55], v[76:79], v[196:199], v[52:55]
    ds_read_b64_tr_b16 v[244:245], v3 offset:9232
    ds_read_b64_tr_b16 v[246:247], v3 offset:10768
    v_permlane16_swap_b32 v202, v206
    v_permlane16_swap_b32 v203, v207
    s_waitcnt lgkmcnt(0)
    s_nop 0
    v_mfma_f32_16x16x32_bf16 v[32:35], v[224:227], v[200:203], v[32:35]
    ds_read_b64_tr_b16 v[56:57], v2 offset:12288
    ds_read_b64_tr_b16 v[58:59], v2 offset:13824
    v_cvt_pk_bf16_f32 v208, v144, v145
    v_cvt_pk_bf16_f32 v209, v146, v147
    v_mfma_f32_16x16x32_bf16 v[36:39], v[228:231], v[200:203], v[36:39]
    ds_read_b64_tr_b16 v[60:61], v2 offset:12296
    ds_read_b64_tr_b16 v[62:63], v2 offset:13832
    v_cvt_pk_bf16_f32 v212, v148, v149
    v_cvt_pk_bf16_f32 v213, v150, v151
    v_mfma_f32_16x16x32_bf16 v[40:43], v[232:235], v[200:203], v[40:43]
    ds_read_b64_tr_b16 v[64:65], v2 offset:12304
    ds_read_b64_tr_b16 v[66:67], v2 offset:13840
    v_cvt_pk_bf16_f32 v210, v152, v153
    v_cvt_pk_bf16_f32 v211, v154, v155
    v_mfma_f32_16x16x32_bf16 v[44:47], v[236:239], v[204:207], v[44:47]
    ds_read_b64_tr_b16 v[68:69], v3 offset:12288
    ds_read_b64_tr_b16 v[70:71], v3 offset:13824
    v_cvt_pk_bf16_f32 v214, v156, v157
    v_cvt_pk_bf16_f32 v215, v158, v159
    v_mfma_f32_16x16x32_bf16 v[48:51], v[240:243], v[204:207], v[48:51]
    ds_read_b64_tr_b16 v[72:73], v3 offset:12296
    ds_read_b64_tr_b16 v[74:75], v3 offset:13832
    v_permlane16_swap_b32 v208, v212
    v_permlane16_swap_b32 v209, v213
    v_mfma_f32_16x16x32_bf16 v[52:55], v[244:247], v[204:207], v[52:55]
    ds_read_b64_tr_b16 v[76:77], v3 offset:12304
    ds_read_b64_tr_b16 v[78:79], v3 offset:13840
    v_permlane16_swap_b32 v210, v214
    v_permlane16_swap_b32 v211, v215
    s_waitcnt lgkmcnt(0)
    s_nop 0
    v_mfma_f32_16x16x32_bf16 v[32:35], v[56:59], v[208:211], v[32:35]
    ds_read_b64_tr_b16 v[224:225], v2 offset:15360
    ds_read_b64_tr_b16 v[226:227], v2 offset:16896
    v_cvt_pk_bf16_f32 v216, v160, v161
    v_cvt_pk_bf16_f32 v217, v162, v163
    v_mfma_f32_16x16x32_bf16 v[36:39], v[60:63], v[208:211], v[36:39]
    ds_read_b64_tr_b16 v[228:229], v2 offset:15368
    ds_read_b64_tr_b16 v[230:231], v2 offset:16904
    v_cvt_pk_bf16_f32 v220, v164, v165
    v_cvt_pk_bf16_f32 v221, v166, v167
    v_mfma_f32_16x16x32_bf16 v[40:43], v[64:67], v[208:211], v[40:43]
    ds_read_b64_tr_b16 v[232:233], v2 offset:15376
    ds_read_b64_tr_b16 v[234:235], v2 offset:16912
    v_cvt_pk_bf16_f32 v218, v168, v169
    v_cvt_pk_bf16_f32 v219, v170, v171
    v_mfma_f32_16x16x32_bf16 v[44:47], v[68:71], v[212:215], v[44:47]
    ds_read_b64_tr_b16 v[236:237], v3 offset:15360
    ds_read_b64_tr_b16 v[238:239], v3 offset:16896
    v_cvt_pk_bf16_f32 v222, v172, v173
    v_cvt_pk_bf16_f32 v223, v174, v175
    v_mfma_f32_16x16x32_bf16 v[48:51], v[72:75], v[212:215], v[48:51]
    ds_read_b64_tr_b16 v[240:241], v3 offset:15368
    ds_read_b64_tr_b16 v[242:243], v3 offset:16904
    v_permlane16_swap_b32 v216, v220
    v_permlane16_swap_b32 v217, v221
    v_mfma_f32_16x16x32_bf16 v[52:55], v[76:79], v[212:215], v[52:55]
    ds_read_b64_tr_b16 v[244:245], v3 offset:15376
    ds_read_b64_tr_b16 v[246:247], v3 offset:16912
    v_permlane16_swap_b32 v218, v222
    v_permlane16_swap_b32 v219, v223
    s_waitcnt lgkmcnt(0)
    s_nop 0
    v_mfma_f32_16x16x32_bf16 v[32:35], v[224:227], v[216:219], v[32:35]
    v_mfma_f32_16x16x32_bf16 v[36:39], v[228:231], v[216:219], v[36:39]
    v_mfma_f32_16x16x32_bf16 v[40:43], v[232:235], v[216:219], v[40:43]
    v_mfma_f32_16x16x32_bf16 v[44:47], v[236:239], v[220:223], v[44:47]
    v_mfma_f32_16x16x32_bf16 v[48:51], v[240:243], v[220:223], v[48:51]
    v_mfma_f32_16x16x32_bf16 v[52:55], v[244:247], v[220:223], v[52:55]
    v_mov_b32 v224, v17
    v_mov_b32 v226, v17
    v_mov_b32 v225, v248
    v_mov_b32 v227, v249
    v_permlane16_swap_b32 v224, v226

    s_barrier
    ds_write_b128 v4, v[32:35] offset:0
    ds_write_b128 v4, v[36:39] offset:16
    ds_write_b128 v4, v[40:43] offset:32
    s_mov_b64 exec, 0xffff
    ds_write_b64 v5, v[224:225] offset:3328
    s_mov_b64 exec, -1
    ds_write_b128 v4, v[44:47] offset:4096
    ds_write_b128 v4, v[48:51] offset:4112
    ds_write_b128 v4, v[52:55] offset:4128
    s_mov_b64 exec, 0xffff
    ds_write_b64 v5, v[226:227] offset:7424
    s_mov_b64 exec, -1
    s_waitcnt lgkmcnt(0)
    s_barrier
    ds_read_b64 v[32:33], v7 offset:3328
    ds_read_b64 v[34:35], v7 offset:19712
    ds_read_b64 v[48:49], v7 offset:3392
    ds_read_b64 v[50:51], v7 offset:19776
    ds_read_b64 v[36:37], v6 offset:0
    ds_read_b64 v[38:39], v6 offset:8
    ds_read_b64 v[40:41], v6 offset:16
    ds_read_b64 v[42:43], v6 offset:16384
    ds_read_b64 v[44:45], v6 offset:16392
    ds_read_b64 v[46:47], v6 offset:16400
    s_waitcnt lgkmcnt(8)
    ds_read_b64 v[52:53], v6 offset:1664
    ds_read_b64 v[54:55], v6 offset:1672
    ds_read_b64 v[56:57], v6 offset:1680
    ds_read_b64 v[58:59], v6 offset:18048
    ds_read_b64 v[60:61], v6 offset:18056
    ds_read_b64 v[62:63], v6 offset:18064
    s_waitcnt lgkmcnt(12)
    v_max_f32 v64, v32, v34
    v_max_f32 v72, v48, v50
    v_sub_f32 v65, v32, v64
    v_sub_f32 v73, v48, v72
    v_sub_f32 v66, v34, v64
    v_sub_f32 v74, v50, v72
    v_exp_f32 v65, v65
    v_exp_f32 v73, v73
    v_exp_f32 v66, v66
    v_exp_f32 v74, v74
    v_mul_f32 v67, v33, v65
    v_mul_f32 v75, v49, v73
    v_fmac_f32 v67, v35, v66
    v_fmac_f32 v75, v51, v74
    v_rcp_f32 v68, v67
    v_rcp_f32 v76, v75
    v_log_f32 v69, v67
    v_log_f32 v77, v75
    v_mul_f32 v65, v65, v68
    v_mul_f32 v73, v73, v76
    v_mul_f32 v66, v66, v68
    v_mul_f32 v74, v74, v76
    v_add_f32 v69, v69, v64
    v_add_f32 v77, v77, v72
    v_lshlrev_b32 v70, 16, v69
    v_lshlrev_b32 v78, 16, v77
    v_and_b32 v71, 0xffff0000, v69
    v_and_b32 v79, 0xffff0000, v77
    v_cndmask_b32 v70, v71, v70, s[26:27]
    v_cndmask_b32 v78, v79, v78, s[26:27]
    v_or_b32 v83, s89, v70
    v_or_b32 v87, s89, v78
    s_waitcnt lgkmcnt(6)
    v_mul_f32 v36, v36, v65
    v_mul_f32 v37, v37, v65
    v_mul_f32 v38, v38, v65
    v_mul_f32 v39, v39, v65
    v_mul_f32 v40, v40, v65
    v_mul_f32 v41, v41, v65
    v_fmac_f32 v36, v42, v66
    v_fmac_f32 v37, v43, v66
    v_fmac_f32 v38, v44, v66
    v_fmac_f32 v39, v45, v66
    v_fmac_f32 v40, v46, v66
    v_fmac_f32 v41, v47, v66
    v_cvt_pk_bf16_f32 v80, v36, v37
    v_cvt_pk_bf16_f32 v81, v38, v39
    v_cvt_pk_bf16_f32 v82, v40, v41
    buffer_store_dwordx4 v[80:83], v23, s[56:59], s24 offen sc1
    s_waitcnt lgkmcnt(0)
    v_mul_f32 v52, v52, v73
    v_mul_f32 v53, v53, v73
    v_mul_f32 v54, v54, v73
    v_mul_f32 v55, v55, v73
    v_mul_f32 v56, v56, v73
    v_mul_f32 v57, v57, v73
    v_fmac_f32 v52, v58, v74
    v_fmac_f32 v53, v59, v74
    v_fmac_f32 v54, v60, v74
    v_fmac_f32 v55, v61, v74
    v_fmac_f32 v56, v62, v74
    v_fmac_f32 v57, v63, v74
    v_cvt_pk_bf16_f32 v84, v52, v53
    v_cvt_pk_bf16_f32 v85, v54, v55
    v_cvt_pk_bf16_f32 v86, v56, v57
    buffer_store_dwordx4 v[84:87], v23, s[56:59], s25 offen sc1
    s_branch L_end
L_end:
    s_endpgm
.section .rodata,"a"
.p2align 6
.amdhsa_kernel standalone__detection_seg_mask2former__vision_kernel
  .amdhsa_next_free_vgpr 256
  .amdhsa_next_free_sgpr 102
  .amdhsa_accum_offset 256
  .amdhsa_group_segment_fixed_size 0
  .amdhsa_kernarg_size 96
  .amdhsa_user_sgpr_count 2
  .amdhsa_user_sgpr_kernarg_segment_ptr 1
  .amdhsa_system_sgpr_workgroup_id_x 1
.end_amdhsa_kernel
```
